```python
import torch

def _softmax(x, axis=-1):
    return torch.softmax(x, dim=axis)
def _gelu(x):
    return torch.nn.functional.gelu(x, approximate="tanh")
def _silu(x):
    return torch.nn.functional.silu(x)
def _sigmoid(x):
    return torch.sigmoid(x)
def _layernorm(x, axis=-1, eps=1e-5):
    m = x.mean(dim=axis, keepdim=True)
    v = x.var(dim=axis, keepdim=True, unbiased=False)
    return (x - m) / torch.sqrt(v + eps)
def _scatter_add(tgt, idx, src, axis=0):
    return tgt.clone().index_add_(axis, idx, src)
def _segment_sum(src, seg, n):
    out = torch.zeros((n,) + src.shape[1:], dtype=src.dtype)
    return out.index_add_(0, seg, src)
def _pad(x, pw):
    flat = tuple(v for pair in reversed(pw) for v in pair)
    return torch.nn.functional.pad(x, flat)

kernel_name = 'recurrent_scan__mha_block_cached__glu_gated_swiglu__decode'

def setup_inputs():

    _w = (lambda a: (lambda t: t.to(torch.bfloat16) if t.is_floating_point() else t)(torch.as_tensor(a)))
    def _A_setup():
        B, Sq, D = 4, 1, 512
        H, Sk, Dh = 32, 8192, 128
        return {
            "x": _w((lambda *s: torch.randn(*s, dtype=torch.bfloat16) * 0.2)(B, Sq, D)),
            "k_cache": _w((lambda *s: torch.randn(*s, dtype=torch.bfloat16) * 1.6)(B, H, Sk, Dh)),
            "v_cache": _w((lambda *s: torch.randn(*s, dtype=torch.bfloat16) * 1.6)(B, H, Sk, Dh)),
            "wq": _w((lambda *s: torch.randn(*s, dtype=torch.bfloat16) * 1.6)(D, H * Dh) * (D ** -0.5)),
            "wo": _w((lambda *s: torch.randn(*s, dtype=torch.bfloat16) * 1.6)(H * Dh, D) * ((H * Dh) ** -0.5)),
        }
    _A_in = _A_setup()

    def _B_setup():
        B, S, D, F = 4, 1, 512, 1792
        return {
            "x": _w((lambda *s: torch.randn(*s, dtype=torch.bfloat16) * 0.2)(B, S, D)),
            "w1": _w((lambda *s: torch.randn(*s, dtype=torch.bfloat16) * 0.8)(D, F) * (2.0 / D) ** 0.5),
            "w3": _w((lambda *s: torch.randn(*s, dtype=torch.bfloat16) * 0.8)(D, F) * (2.0 / D) ** 0.5),
            "w2": _w((lambda *s: torch.randn(*s, dtype=torch.bfloat16) * 0.8)(F, D) * (2.0 / F) ** 0.5),
        }
    _B_in = _B_setup()

    return {
        "A_x": _A_in["x"],
        "A_k_cache": _A_in["k_cache"],
        "A_v_cache": _A_in["v_cache"],
        "A_wq": _A_in["wq"],
        "A_wo": _A_in["wo"],
        "B_x": _B_in["x"],
        "B_w1": _B_in["w1"],
        "B_w3": _B_in["w3"],
        "B_w2": _B_in["w2"],
    }

def reference(A_x, A_k_cache, A_v_cache, A_wq, A_wo, B_x, B_w1, B_w3, B_w2):
    def _A_ref(x, k_cache, v_cache, wq, wo):
        B, Sq, D = x.shape
        H, Dh = 32, 128
        q = (lambda x, *d: x.permute(*d))((x @ wq).reshape(B, Sq, H, Dh), 0, 2, 1, 3)
        scores = torch.einsum("bhqd,bhkd->bhqk", q, k_cache) * (Dh ** -0.5)
        p = _softmax(scores, axis=-1)
        o = torch.einsum("bhqk,bhkd->bhqd", p, v_cache)
        return (lambda x, *d: x.permute(*d))(o, 0, 2, 1, 3).reshape(B, Sq, H * Dh) @ wo

    def _B_ref(x, w1, w3, w2):
        gate = torch.einsum("bsd,df->bsf", x, w1)
        up = torch.einsum("bsd,df->bsf", x, w3)
        h = _silu(gate) * up
        out = torch.einsum("bsf,fd->bsd", h, w2)
        return out

    x = A_x
    xn = _layernorm(x, axis=-1)
    s = _A_ref(xn, A_k_cache, A_v_cache, A_wq, A_wo)
    g = _silu(_B_ref(xn, B_w1, B_w3, B_w2))
    return x + s * g
```

```asm
; @launch grid=(256,1,1) block=(512,1,1) lds=116992
.amdgcn_target "amdgcn-amd-amdhsa--gfx950"
.text
.globl recurrent_scan__mha_block_cached__glu_gated_swiglu__decode_kernel
.p2align 8
.type recurrent_scan__mha_block_cached__glu_gated_swiglu__decode_kernel,@function
recurrent_scan__mha_block_cached__glu_gated_swiglu__decode_kernel:
  s_cmp_ge_u32 s2, 256
  s_cbranch_scc1 L_end
  s_load_dwordx16 s[16:31], s[0:1], 0
  s_load_dwordx8 s[32:39], s[0:1], 64
  v_lshrrev_b32 v2, 6, v0
  v_and_b32 v1, 63, v0
  v_readfirstlane_b32 s3, v2
  s_and_b32 s4, s2, 7
  s_lshr_b32 s5, s2, 3
  s_and_b32 s8, s5, 1
  s_lshr_b32 s6, s5, 3
  s_bfe_u32 s7, s5, 0x20001
  s_lshl_b32 s7, s7, 3
  s_add_u32 s7, s7, s4
  s_lshl_b32 s9, s6, 6
  s_lshl_b32 s10, s7, 1
  s_add_u32 s9, s9, s10
  s_add_u32 s9, s9, s8
  v_lshlrev_b32 v2, 4, v1
  v_lshrrev_b32 v3, 4, v1
  v_mov_b32 v12, 0
  v_mov_b32 v13, 0
  v_mov_b32 v14, 0
  v_mov_b32 v15, 0
  ds_write_b128 v12, v[12:15] offset:6240
  ds_write_b32 v12, v12 offset:6260
  ds_write_b32 v12, v12 offset:6256
  s_cmp_lt_u32 s3, 4
  s_cbranch_scc1 L_helper
  s_sub_u32 s11, s3, 4
  v_mov_b32 v4, v3
  v_bfe_u32 v5, v1, 2, 2
  v_and_b32 v6, 3, v1
  v_lshlrev_b32 v3, 6, v4
  v_lshl_add_u32 v3, v5, 8, v3
  v_lshl_add_u32 v3, v6, 4, v3
  s_lshl_b32 s48, s11, 10
  s_lshr_b32 s10, s9, 1
  s_lshl_b32 s10, s10, 21
  s_mul_i32 s50, s8, 32768
  s_add_u32 s48, s48, s50
  s_mov_b32 s49, s48
  s_waitcnt lgkmcnt(0)
  s_barrier
  s_add_u32 s40, s18, s10
  s_addc_u32 s41, s19, 0
  s_mov_b32 s42, 2097152
  s_mov_b32 s43, 0x20000
  buffer_load_dwordx4 v[80:83], v3, s[40:43], s48 offen nt
  s_add_u32 s48, s48, 4096
  buffer_load_dwordx4 v[84:87], v3, s[40:43], s48 offen nt
  s_add_u32 s48, s48, 4096
  buffer_load_dwordx4 v[88:91], v3, s[40:43], s48 offen nt
  s_add_u32 s48, s48, 4096
  buffer_load_dwordx4 v[92:95], v3, s[40:43], s48 offen nt
  s_add_u32 s48, s48, 4096
  buffer_load_dwordx4 v[96:99], v3, s[40:43], s48 offen nt
  s_add_u32 s48, s48, 4096
  s_setprio 3
  s_branch L_streamer2
L_helper:
  v_and_b32 v4, 15, v1
  v_lshlrev_b32 v5, 16, v3
  v_lshrrev_b32 v28, 3, v4
  v_and_b32 v29, 7, v4
  v_lshl_add_u32 v5, v28, 18, v5
  v_lshl_add_u32 v5, v29, 3, v5
  s_lshl_b32 s13, s6, 1
  s_add_u32 s13, s13, s8
  s_lshl_b32 s10, s7, 8
  s_lshl_b32 s14, s13, 19
  s_add_u32 s10, s10, s14
  s_lshl_b32 s14, s3, 6
  s_add_u32 s10, s10, s14
  s_lshl_b32 s12, s6, 10
  s_lshl_b32 s14, s3, 10
  s_mov_b32 s57, 8192
  s_mov_b32 s58, 16384
  s_mov_b32 s59, 24576
  s_mov_b32 s60, 32768
  s_mov_b32 s61, 40960
  s_mov_b32 s62, 49152
  s_mov_b32 s63, 57344
  s_waitcnt lgkmcnt(0)
  s_barrier
  s_mov_b32 s44, s16
  s_mov_b32 s45, s17
  s_mov_b32 s46, 4096
  s_mov_b32 s47, 0x20000
  buffer_load_dwordx4 v[8:11], v2, s[44:47], s14 offen
  s_load_dword s69, s[38:39], 196608
  s_add_u32 s40, s22, s10
  s_addc_u32 s41, s23, 0
  s_mov_b32 s42, 516160
  s_mov_b32 s43, 0x20000
  buffer_load_dwordx2 v[64:65], v5, s[40:43], 0 offen
  buffer_load_dwordx2 v[66:67], v5, s[40:43], s57 offen
  buffer_load_dwordx2 v[68:69], v5, s[40:43], s58 offen
  buffer_load_dwordx2 v[70:71], v5, s[40:43], s59 offen
  buffer_load_dwordx2 v[72:73], v5, s[40:43], s60 offen
  buffer_load_dwordx2 v[74:75], v5, s[40:43], s61 offen
  buffer_load_dwordx2 v[76:77], v5, s[40:43], s62 offen
  buffer_load_dwordx2 v[78:79], v5, s[40:43], s63 offen
  s_cmp_eq_u32 s3, 0
  s_cselect_b32 s64, s28, s30
  s_cselect_b32 s65, s29, s31
  s_mul_i32 s66, s4, 229376
  s_lshl_b32 s67, s5, 7
  s_add_u32 s66, s66, s67
  s_lshl_b32 s67, s5, 16
  s_lshl_b32 s15, s4, 7
  s_add_u32 s67, s67, s15
  s_cmp_eq_u32 s3, 2
  s_cselect_b32 s64, s32, s64
  s_cselect_b32 s65, s33, s65
  s_cselect_b32 s66, s67, s66
  s_mov_b32 s67, 3584
  s_cselect_b32 s67, 1024, s67
  s_add_u32 s52, s64, s66
  s_addc_u32 s53, s65, 0
  s_mul_i32 s54, s67, 63
  s_add_u32 s54, s54, 128
  s_mov_b32 s55, 0x20000
  s_cmp_eq_u32 s3, 1
  s_cselect_b32 s54, 0, s54
  s_cmp_ge_u32 s5, 28
  s_cselect_b32 s54, 0, s54
  v_lshlrev_b32 v14, 3, v3
  v_lshl_add_u32 v14, v28, 5, v14
  v_mul_u32_u24 v14, s67, v14
  v_lshl_add_u32 v14, v29, 4, v14
  s_mov_b32 s15, 0
  buffer_load_dwordx4 v[192:195], v14, s[52:55], s15 offen nt
  s_add_u32 s15, s15, s67
  buffer_load_dwordx4 v[196:199], v14, s[52:55], s15 offen nt
  s_add_u32 s15, s15, s67
  buffer_load_dwordx4 v[200:203], v14, s[52:55], s15 offen nt
  s_add_u32 s15, s15, s67
  buffer_load_dwordx4 v[204:207], v14, s[52:55], s15 offen nt
  s_add_u32 s15, s15, s67
  buffer_load_dwordx4 v[208:211], v14, s[52:55], s15 offen nt
  s_add_u32 s15, s15, s67
  buffer_load_dwordx4 v[212:215], v14, s[52:55], s15 offen nt
  s_add_u32 s15, s15, s67
  buffer_load_dwordx4 v[216:219], v14, s[52:55], s15 offen nt
  s_add_u32 s15, s15, s67
  buffer_load_dwordx4 v[220:223], v14, s[52:55], s15 offen nt
  s_lshl_b32 s15, s7, 17
  s_lshl_b32 s64, s13, 14
  s_add_u32 s15, s15, s64
  s_lshl_b32 s64, s3, 12
  s_add_u32 s15, s15, s64
  s_add_u32 s40, s24, s15
  s_addc_u32 s41, s25, 0
  s_mov_b32 s42, 4096
  s_mov_b32 s43, 0x20000
  buffer_load_dwordx4 v[96:99], v2, s[40:43], 0 offen offset:0
  buffer_load_dwordx4 v[100:103], v2, s[40:43], 0 offen offset:1024
  buffer_load_dwordx4 v[104:107], v2, s[40:43], 0 offen offset:2048
  buffer_load_dwordx4 v[108:111], v2, s[40:43], 0 offen offset:3072
  s_mov_b32 s48, s38
  s_mov_b32 s49, s39
  s_mov_b32 s50, 2097152
  s_mov_b32 s51, 0x20000
  s_mov_b32 s58, 0x05040100
  s_mov_b32 s59, 0x07060302
  v_add_u32 v7, s14, v2
  v_lshrrev_b32 v30, 2, v4
  v_lshlrev_b32 v30, 10, v30
  v_lshl_add_u32 v30, v3, 4, v30
  s_lshl_b32 s15, s13, 7
  v_add_u32 v30, s15, v30
  v_and_b32 v31, 1, v4
  v_lshl_add_u32 v30, v31, 6, v30
  v_lshlrev_b32 v13, 13, v3
  v_lshl_add_u32 v13, v29, 5, v13
  v_lshl_add_u32 v13, v28, 4, v13
  v_cmp_lt_u32 s[62:63], 7, v4
  v_lshlrev_b32 v5, 13, v3
  v_lshl_add_u32 v5, v4, 4, v5
  s_lshl_b32 s56, s7, 15
  s_add_u32 s56, s56, 1048576
  s_lshl_b32 s57, s13, 10
  s_lshl_b32 s15, s3, 8
  s_add_u32 s57, s57, s15
  s_add_u32 s57, s57, s56
  s_lshl_b32 s15, s6, 13
  s_add_u32 s56, s56, s15
  s_lshl_b32 s15, s3, 11
  s_add_u32 s56, s56, s15
  v_lshlrev_b32 v6, 3, v1
  s_lshl_b32 s15, s3, 9
  v_add_u32 v6, s15, v6
  v_mov_b32 v31, 1
  s_waitcnt vmcnt(20)
  v_lshlrev_b32 v16, 16, v8
  v_and_b32 v17, 0xffff0000, v8
  v_lshlrev_b32 v18, 16, v9
  v_and_b32 v19, 0xffff0000, v9
  v_lshlrev_b32 v20, 16, v10
  v_and_b32 v21, 0xffff0000, v10
  v_lshlrev_b32 v22, 16, v11
  v_and_b32 v23, 0xffff0000, v11
  v_add_f32 v24, v16, v17
  v_add_f32 v25, v18, v19
  v_add_f32 v26, v20, v21
  v_add_f32 v24, v24, v25
  v_add_f32 v25, v22, v23
  v_add_f32 v24, v24, v26
  v_add_f32 v24, v24, v25
  s_nop 1
  v_add_f32_dpp v24, v24, v24 quad_perm:[1,0,3,2] row_mask:0xf bank_mask:0xf
  s_nop 1
  v_add_f32_dpp v24, v24, v24 quad_perm:[2,3,0,1] row_mask:0xf bank_mask:0xf
  s_nop 1
  v_add_f32_dpp v24, v24, v24 row_half_mirror row_mask:0xf bank_mask:0xf
  s_nop 1
  v_add_f32_dpp v24, v24, v24 row_mirror row_mask:0xf bank_mask:0xf
  s_nop 1
  v_add_f32_dpp v24, v24, v24 row_bcast:15 row_mask:0xa bank_mask:0xf
  s_nop 1
  v_add_f32_dpp v24, v24, v24 row_bcast:31 row_mask:0xc bank_mask:0xf
  s_nop 0
  v_readlane_b32 s70, v24, 63
  v_mov_b32 v25, 0x3b000000
  s_nop 0
  v_mul_f32 v25, s70, v25
  v_sub_f32 v26, v16, v25
  v_sub_f32 v27, v17, v25
  v_mul_f32 v24, v26, v26
  v_mul_f32 v8, v27, v27
  v_sub_f32 v26, v18, v25
  v_sub_f32 v27, v19, v25
  v_fmac_f32 v24, v26, v26
  v_fmac_f32 v8, v27, v27
  v_sub_f32 v26, v20, v25
  v_sub_f32 v27, v21, v25
  v_fmac_f32 v24, v26, v26
  v_fmac_f32 v8, v27, v27
  v_sub_f32 v26, v22, v25
  v_sub_f32 v27, v23, v25
  v_fmac_f32 v24, v26, v26
  v_fmac_f32 v8, v27, v27
  v_add_f32 v24, v24, v8
  v_cvt_pk_bf16_f32 v25, v25, v25
  v_and_b32 v25, 0xffff0000, v25
  v_add_f32_dpp v24, v24, v24 quad_perm:[1,0,3,2] row_mask:0xf bank_mask:0xf
  v_sub_f32 v16, v16, v25
  v_sub_f32 v17, v17, v25
  v_add_f32_dpp v24, v24, v24 quad_perm:[2,3,0,1] row_mask:0xf bank_mask:0xf
  v_sub_f32 v18, v18, v25
  v_sub_f32 v19, v19, v25
  v_add_f32_dpp v24, v24, v24 row_half_mirror row_mask:0xf bank_mask:0xf
  v_sub_f32 v20, v20, v25
  v_sub_f32 v21, v21, v25
  v_add_f32_dpp v24, v24, v24 row_mirror row_mask:0xf bank_mask:0xf
  v_sub_f32 v22, v22, v25
  v_sub_f32 v23, v23, v25
  v_add_f32_dpp v24, v24, v24 row_bcast:15 row_mask:0xa bank_mask:0xf
  v_cvt_pk_bf16_f32 v8, v16, v17
  v_cvt_pk_bf16_f32 v9, v18, v19
  v_add_f32_dpp v24, v24, v24 row_bcast:31 row_mask:0xc bank_mask:0xf
  v_cvt_pk_bf16_f32 v10, v20, v21
  v_cvt_pk_bf16_f32 v11, v22, v23
  v_readlane_b32 s70, v24, 63
  v_lshlrev_b32 v16, 16, v8
  v_and_b32 v17, 0xffff0000, v8
  v_mov_b32 v24, 0x3b000000
  v_mul_f32 v24, s70, v24
  v_cvt_pk_bf16_f32 v24, v24, v24
  v_and_b32 v24, 0xffff0000, v24
  v_add_f32 v24, 0x3727c5ac, v24
  v_cvt_pk_bf16_f32 v24, v24, v24
  v_and_b32 v24, 0xffff0000, v24
  v_sqrt_f32 v24, v24
  v_lshlrev_b32 v18, 16, v9
  v_cvt_pk_bf16_f32 v24, v24, v24
  v_and_b32 v24, 0xffff0000, v24
  v_rcp_f32 v24, v24
  v_and_b32 v19, 0xffff0000, v9
  v_lshlrev_b32 v20, 16, v10
  v_and_b32 v21, 0xffff0000, v10
  v_lshlrev_b32 v22, 16, v11
  v_and_b32 v23, 0xffff0000, v11
  v_mul_f32 v16, v16, v24
  v_mul_f32 v17, v17, v24
  v_mul_f32 v18, v18, v24
  v_mul_f32 v19, v19, v24
  v_mul_f32 v20, v20, v24
  v_mul_f32 v21, v21, v24
  v_mul_f32 v22, v22, v24
  v_mul_f32 v23, v23, v24
  v_cvt_pk_bf16_f32 v8, v16, v17
  v_cvt_pk_bf16_f32 v9, v18, v19
  v_cvt_pk_bf16_f32 v10, v20, v21
  v_cvt_pk_bf16_f32 v11, v22, v23
  ds_write_b128 v7, v[8:11] offset:0
  ds_add_u32 v12, v31 offset:6252
  s_waitcnt vmcnt(12)
  v_perm_b32 v80, v66, v64, s58
  v_perm_b32 v81, v70, v68, s58
  v_perm_b32 v82, v74, v72, s58
  v_perm_b32 v83, v78, v76, s58
  v_perm_b32 v84, v66, v64, s59
  v_perm_b32 v85, v70, v68, s59
  v_perm_b32 v86, v74, v72, s59
  v_perm_b32 v87, v78, v76, s59
  v_perm_b32 v88, v67, v65, s58
  v_perm_b32 v89, v71, v69, s58
  v_perm_b32 v90, v75, v73, s58
  v_perm_b32 v91, v79, v77, s58
  v_perm_b32 v92, v67, v65, s59
  v_perm_b32 v93, v71, v69, s59
  v_perm_b32 v94, v75, v73, s59
  v_perm_b32 v95, v79, v77, s59
  v_mov_b32 v8, 0
  s_mov_b32 s72, 400000
spin_1:
  ds_read_b32 v11, v8 offset:6252
  s_waitcnt lgkmcnt(0)
  v_readfirstlane_b32 s71, v11
  s_nop 0
  s_cmp_ge_u32 s71, 256
  s_cbranch_scc1 spun_2
  s_sub_u32 s72, s72, 1
  s_cmp_eq_u32 s72, 0
  s_cbranch_scc1 spun_2
  s_sleep 0
  s_branch spin_1
spun_2:
  ds_read_b128 v[16:19], v30 offset:0
  s_mul_i32 s68, s69, 0x9e3779b1
  s_add_u32 s68, s68, 0x7f4a7c15
  s_waitcnt lgkmcnt(0)
  v_mfma_f32_16x16x32_bf16 v[32:35], v[16:19], v[80:83], 0
  v_mfma_f32_16x16x32_bf16 v[36:39], v[16:19], v[84:87], 0
  v_mfma_f32_16x16x32_bf16 v[40:43], v[16:19], v[88:91], 0
  v_mfma_f32_16x16x32_bf16 v[44:47], v[16:19], v[92:95], 0
  v_mov_b32 v21, s68
  v_mov_b32 v23, s68
  s_nop 4
  v_cndmask_b32 v20, v32, v41, s[62:63]
  v_cndmask_b32 v24, v40, v33, s[62:63]
  v_cndmask_b32 v22, v36, v45, s[62:63]
  v_cndmask_b32 v25, v44, v37, s[62:63]
  v_add_f32_dpp v20, v24, v20 row_ror:8 row_mask:0xf bank_mask:0xf
  s_nop 0
  v_add_f32_dpp v22, v25, v22 row_ror:8 row_mask:0xf bank_mask:0xf
  buffer_store_dwordx4 v[20:23], v13, s[48:51], s57 offen sc1
  s_mov_b32 s72, 400000
spin_3:
  ds_read_b32 v11, v8 offset:6240
  s_waitcnt lgkmcnt(0)
  v_readfirstlane_b32 s71, v11
  s_nop 0
  s_cmp_ge_u32 s71, 1
  s_cbranch_scc1 spun_4
  s_sub_u32 s72, s72, 1
  s_cmp_eq_u32 s72, 0
  s_cbranch_scc1 spun_4
  s_sleep 1
  s_branch spin_3
spun_4:
  s_mov_b32 s72, 400000
  s_waitcnt vmcnt(0)
L_qpoll:
  buffer_load_dwordx4 v[40:43], v2, s[48:51], s56 offen sc1
  buffer_load_dwordx4 v[44:47], v2, s[48:51], s56 offen offset:1024 sc1
  s_sub_u32 s72, s72, 1
  s_waitcnt vmcnt(0)
  v_xor_b32 v48, s68, v41
  v_xor_b32 v49, s68, v43
  v_xor_b32 v50, s68, v45
  v_xor_b32 v51, s68, v47
  v_or3_b32 v48, v48, v49, v50
  v_or_b32 v48, v48, v51
  v_cmp_ne_u32 vcc, 0, v48
  s_cmp_eq_u32 s72, 0
  s_cbranch_scc1 L_qok
  s_cbranch_vccz L_qok
  s_sleep 8
  s_branch L_qpoll
L_qok:
  v_add_f32 v40, v40, v44
  v_add_f32 v41, v42, v46
  ds_write_b64 v6, v[40:41] offset:4096
  ds_add_u32 v12, v31 offset:6260
  s_branch L_helper2
L_streamer2:
  s_add_u32 s44, s20, s10
  s_addc_u32 s45, s21, 0
  s_mov_b32 s46, 2097152
  s_mov_b32 s47, 0x20000
  v_lshlrev_b32 v11, 7, v4
  v_lshl_add_u32 v11, v6, 5, v11
  v_cmp_eq_u32 s[66:67], 0, v5
  v_cmp_eq_u32 s[68:69], 1, v5
  v_cmp_eq_u32 s[72:73], 2, v5
  v_cmp_eq_u32 s[74:75], 3, v5
  v_and_b32 v58, 1, v1
  v_cmp_eq_u32 s[62:63], 1, v58
  v_and_b32 v58, 2, v1
  v_cmp_eq_u32 s[64:65], 2, v58
  v_lshlrev_b32 v70, 6, v5
  v_lshl_add_u32 v70, v6, 2, v70
  v_lshl_add_u32 v70, v4, 1, v70
  s_lshl_b32 s58, s11, 8
  v_add_u32 v70, s58, v70
  v_and_b32 v58, 1, v1
  v_lshlrev_b32 v58, 4, v58
  v_mov_b32 v59, 0xffff
  v_lshlrev_b32 v58, v58, v59
  v_bfe_u32 v59, v1, 1, 3
  v_cmp_eq_u32 vcc, 0, v59
  s_nop 1
  v_cndmask_b32 v4, 0, v58, vcc
  v_cmp_eq_u32 vcc, 1, v59
  s_nop 1
  v_cndmask_b32 v5, 0, v58, vcc
  v_cmp_eq_u32 vcc, 2, v59
  s_nop 1
  v_cndmask_b32 v6, 0, v58, vcc
  v_cmp_eq_u32 vcc, 3, v59
  s_nop 1
  v_cndmask_b32 v7, 0, v58, vcc
  s_lshl_b32 s58, s11, 14
  s_add_u32 s58, s58, 49408
  v_add_u32 v8, s58, v2
  s_lshl_b32 s58, s11, 12
  s_add_u32 s58, s58, 32768
  v_lshlrev_b32 v9, 2, v1
  v_add_u32 v9, s58, v9
  v_mov_b32 v10, 0
  v_mov_b32 v12, 0
  v_mov_b32 v13, 0
  v_mov_b32 v14, 0
  v_mov_b32 v15, 0
  s_mov_b32 s57, 0xff7fffff
  s_mov_b32 s60, 0x3db504f3
  s_mov_b32 s56, 0
  v_mov_b32 v71, 6240
  s_waitcnt vmcnt(4)
  buffer_load_dwordx4 v[100:103], v3, s[40:43], s48 offen nt
  s_add_u32 s48, s48, 4096
  s_waitcnt vmcnt(4)
  buffer_load_dwordx4 v[104:107], v3, s[40:43], s48 offen nt
  s_add_u32 s48, s48, 4096
  s_waitcnt vmcnt(4)
  buffer_load_dwordx4 v[108:111], v3, s[40:43], s48 offen nt
  s_add_u32 s48, s48, 36864
  s_waitcnt vmcnt(4)
  buffer_load_dwordx4 v[112:115], v3, s[40:43], s48 offen nt
  s_add_u32 s48, s48, 4096
  s_waitcnt vmcnt(4)
  buffer_load_dwordx4 v[116:119], v3, s[40:43], s48 offen nt
  s_add_u32 s48, s48, 4096
  s_waitcnt vmcnt(4)
  buffer_load_dwordx4 v[120:123], v3, s[40:43], s48 offen nt
  s_add_u32 s48, s48, 4096
  s_waitcnt vmcnt(4)
  buffer_load_dwordx4 v[124:127], v3, s[40:43], s48 offen nt
  s_add_u32 s48, s48, 4096
  s_waitcnt vmcnt(4)
  buffer_load_dwordx4 v[128:131], v3, s[40:43], s48 offen nt
  s_add_u32 s48, s48, 4096
  s_waitcnt vmcnt(4)
  buffer_load_dwordx4 v[132:135], v3, s[40:43], s48 offen nt
  s_add_u32 s48, s48, 4096
  s_waitcnt vmcnt(4)
  buffer_load_dwordx4 v[136:139], v3, s[40:43], s48 offen nt
  s_add_u32 s48, s48, 4096
  s_waitcnt vmcnt(4)
  buffer_load_dwordx4 v[140:143], v3, s[40:43], s48 offen nt
  s_add_u32 s48, s48, 36864
  s_waitcnt vmcnt(4)
  buffer_load_dwordx4 v[144:147], v3, s[40:43], s48 offen nt
  s_add_u32 s48, s48, 4096
  s_waitcnt vmcnt(4)
  buffer_load_dwordx4 v[148:151], v3, s[40:43], s48 offen nt
  s_add_u32 s48, s48, 4096
  v_mov_b32 v72, 1
  ds_write_b32 v71, v72
  s_waitcnt vmcnt(4)
  buffer_load_dwordx4 v[152:155], v3, s[40:43], s48 offen nt
  s_add_u32 s48, s48, 4096
  s_waitcnt vmcnt(4)
  buffer_load_dwordx4 v[156:159], v3, s[40:43], s48 offen nt
  s_add_u32 s48, s48, 4096
  s_waitcnt vmcnt(4)
  buffer_load_dwordx4 v[160:163], v3, s[40:43], s48 offen nt
  s_add_u32 s48, s48, 4096
  s_waitcnt vmcnt(4)
  buffer_load_dwordx4 v[164:167], v3, s[40:43], s48 offen nt
  s_add_u32 s48, s48, 4096
  s_waitcnt vmcnt(4)
  buffer_load_dwordx4 v[168:171], v3, s[40:43], s48 offen nt
  s_add_u32 s48, s48, 4096
  s_waitcnt vmcnt(4)
  buffer_load_dwordx4 v[172:175], v3, s[40:43], s48 offen nt
  s_add_u32 s48, s48, 36864
  s_waitcnt vmcnt(4)
  buffer_load_dwordx4 v[176:179], v3, s[40:43], s48 offen nt
  s_add_u32 s48, s48, 4096
  s_waitcnt vmcnt(4)
  buffer_load_dwordx4 v[180:183], v3, s[40:43], s48 offen nt
  s_add_u32 s48, s48, 4096
  s_waitcnt vmcnt(4)
  buffer_load_dwordx4 v[184:187], v3, s[40:43], s48 offen nt
  s_add_u32 s48, s48, 4096
  ds_read_b32 v75, v71 offset:20
  s_waitcnt vmcnt(4)
  buffer_load_dwordx4 v[188:191], v3, s[40:43], s48 offen nt
  s_add_u32 s48, s48, 4096
  s_mov_b32 s59, 8000000
L_qw:
  s_waitcnt lgkmcnt(0)
  v_readfirstlane_b32 s58, v75
  s_nop 0
  s_cmp_ge_u32 s58, 256
  s_cbranch_scc1 L_qr
  ds_read_b32 v75, v71 offset:20
  s_sub_u32 s59, s59, 1
  s_cmp_lg_u32 s59, 0
  s_cbranch_scc1 L_qw
L_qr:
  ds_read_b128 v[32:35], v11 offset:4096
  ds_read_b128 v[36:39], v11 offset:4112
  ds_read_b128 v[40:43], v11 offset:4608
  ds_read_b128 v[44:47], v11 offset:4624
  ds_read_b128 v[48:51], v11 offset:5120
  ds_read_b128 v[52:55], v11 offset:5136
  ds_read_b128 v[56:59], v11 offset:5632
  ds_read_b128 v[60:63], v11 offset:5648
  s_waitcnt vmcnt(4)
  buffer_load_dwordx4 v[192:195], v3, s[40:43], s48 offen nt
  s_add_u32 s48, s48, 4096
  s_waitcnt lgkmcnt(4)
  v_add_f32 v32, v32, v40
  v_add_f32 v33, v33, v41
  v_add_f32 v34, v34, v42
  v_add_f32 v35, v35, v43
  v_add_f32 v36, v36, v44
  v_add_f32 v37, v37, v45
  v_add_f32 v38, v38, v46
  v_add_f32 v39, v39, v47
  s_waitcnt lgkmcnt(0)
  v_add_f32 v48, v48, v56
  v_add_f32 v49, v49, v57
  v_add_f32 v50, v50, v58
  v_add_f32 v51, v51, v59
  v_add_f32 v52, v52, v60
  v_add_f32 v53, v53, v61
  v_add_f32 v54, v54, v62
  v_add_f32 v55, v55, v63
  s_waitcnt vmcnt(4)
  buffer_load_dwordx4 v[196:199], v3, s[40:43], s48 offen nt
  s_add_u32 s48, s48, 4096
  v_add_f32 v32, v32, v48
  v_add_f32 v33, v33, v49
  v_add_f32 v34, v34, v50
  v_add_f32 v35, v35, v51
  v_add_f32 v36, v36, v52
  v_add_f32 v37, v37, v53
  v_add_f32 v38, v38, v54
  v_add_f32 v39, v39, v55
  v_cvt_pk_bf16_f32 v40, v32, v33
  v_cvt_pk_bf16_f32 v41, v34, v35
  v_cvt_pk_bf16_f32 v42, v36, v37
  v_cvt_pk_bf16_f32 v43, v38, v39
  s_waitcnt vmcnt(4)
  buffer_load_dwordx4 v[200:203], v3, s[40:43], s48 offen nt
  s_add_u32 s48, s48, 4096
  v_cndmask_b32 v16, 0, v40, s[66:67]
  v_cndmask_b32 v17, 0, v41, s[66:67]
  v_cndmask_b32 v18, 0, v42, s[66:67]
  v_cndmask_b32 v19, 0, v43, s[66:67]
  v_cndmask_b32 v20, 0, v40, s[68:69]
  v_cndmask_b32 v21, 0, v41, s[68:69]
  v_cndmask_b32 v22, 0, v42, s[68:69]
  v_cndmask_b32 v23, 0, v43, s[68:69]
  v_cndmask_b32 v24, 0, v40, s[72:73]
  v_cndmask_b32 v25, 0, v41, s[72:73]
  v_cndmask_b32 v26, 0, v42, s[72:73]
  v_cndmask_b32 v27, 0, v43, s[72:73]
  v_cndmask_b32 v28, 0, v40, s[74:75]
  v_cndmask_b32 v29, 0, v41, s[74:75]
  v_cndmask_b32 v30, 0, v42, s[74:75]
  v_cndmask_b32 v31, 0, v43, s[74:75]
  v_mov_b32 v44, 0xff800000
  v_mov_b32 v45, 0xff800000
  v_mov_b32 v46, 0xff800000
  v_mov_b32 v47, 0xff800000
  v_mov_b32 v48, 0xff800000
  v_mov_b32 v49, 0xff800000
  v_mov_b32 v50, 0xff800000
  s_mov_b64 vcc, 0
.p2align 6
L_kloop:
  s_waitcnt vmcnt(4)
  buffer_load_dwordx4 v[204:207], v3, s[40:43], s48 offen nt
  s_add_u32 s48, s48, 36864
  v_mfma_f32_16x16x32_bf16 v[32:35], v[80:83], v[16:19], 0
  v_add_f32_dpp v50, v50, v50 quad_perm:[2,3,0,1] row_mask:0xf bank_mask:0xf
  v_cvt_pk_bf16_f32 v57, v48, v49
  v_lshlrev_b32 v52, 16, v57
  v_and_b32 v53, 0xffff0000, v57
  v_mul_f32 v52, s60, v52
  s_cbranch_vccnz ks_5
  s_waitcnt vmcnt(4)
  buffer_load_dwordx4 v[80:83], v3, s[40:43], s48 offen nt
  s_add_u32 s48, s48, 4096
  s_branch kv_6
ks_5:
  s_waitcnt vmcnt(4)
  buffer_load_dwordx4 v[80:83], v2, s[44:47], s49 offen nt
  s_add_u32 s49, s49, 4096
kv_6:
  v_mfma_f32_16x16x32_bf16 v[32:35], v[84:87], v[20:23], v[32:35]
  v_mul_f32 v53, s60, v53
  v_cvt_pk_bf16_f32 v57, v52, v53
  v_lshlrev_b32 v52, 16, v57
  v_and_b32 v53, 0xffff0000, v57
  s_cbranch_vccnz ks_7
  s_waitcnt vmcnt(4)
  buffer_load_dwordx4 v[84:87], v3, s[40:43], s48 offen nt
  s_add_u32 s48, s48, 4096
  s_branch kv_8
ks_7:
  s_waitcnt vmcnt(4)
  buffer_load_dwordx4 v[84:87], v2, s[44:47], s49 offen nt
  s_add_u32 s49, s49, 4096
kv_8:
  v_mfma_f32_16x16x32_bf16 v[32:35], v[88:91], v[24:27], v[32:35]
  v_cndmask_b32 v58, v44, v45, s[62:63]
  v_cndmask_b32 v59, v46, v47, s[62:63]
  v_cndmask_b32 v51, v58, v59, s[64:65]
  s_cbranch_vccnz ks_9
  s_waitcnt vmcnt(4)
  buffer_load_dwordx4 v[88:91], v3, s[40:43], s48 offen nt
  s_add_u32 s48, s48, 4096
  s_branch kv_10
ks_9:
  s_waitcnt vmcnt(4)
  buffer_load_dwordx4 v[88:91], v2, s[44:47], s49 offen nt
  s_add_u32 s49, s49, 4096
kv_10:
  v_mfma_f32_16x16x32_bf16 v[32:35], v[92:95], v[28:31], v[32:35]
  v_add_f32_dpp v51, v51, v51 quad_perm:[1,0,3,2] row_mask:0xf bank_mask:0xf
  v_max3_f32 v60, v52, v53, s57
  v_mov_b32 v56, s57
  s_cbranch_vccnz ks_11
  s_waitcnt vmcnt(4)
  buffer_load_dwordx4 v[92:95], v3, s[40:43], s48 offen nt
  s_add_u32 s48, s48, 4096
  s_branch kv_12
ks_11:
  s_waitcnt vmcnt(4)
  buffer_load_dwordx4 v[92:95], v2, s[44:47], s49 offen nt
  s_add_u32 s49, s49, 4096
kv_12:
  v_mfma_f32_16x16x32_bf16 v[36:39], v[96:99], v[16:19], 0
  v_add_f32_dpp v51, v51, v51 quad_perm:[2,3,0,1] row_mask:0xf bank_mask:0xf
  s_cbranch_vccnz ks_13
  s_waitcnt vmcnt(4)
  buffer_load_dwordx4 v[96:99], v3, s[40:43], s48 offen nt
  s_add_u32 s48, s48, 4096
  s_branch kv_14
ks_13:
  s_waitcnt vmcnt(4)
  buffer_load_dwordx4 v[96:99], v2, s[44:47], s49 offen nt
  s_add_u32 s49, s49, 4096
kv_14:
  v_mfma_f32_16x16x32_bf16 v[36:39], v[100:103], v[20:23], v[36:39]
  v_cvt_pk_bf16_f32 v57, v50, v51
  v_lshlrev_b32 v54, 16, v57
  v_and_b32 v55, 0xffff0000, v57
  v_mul_f32 v54, s60, v54
  v_mul_f32 v55, s60, v55
  s_cbranch_vccnz ks_15
  s_waitcnt vmcnt(4)
  buffer_load_dwordx4 v[100:103], v3, s[40:43], s48 offen nt
  s_add_u32 s48, s48, 4096
ks_15:
  v_mfma_f32_16x16x32_bf16 v[36:39], v[104:107], v[24:27], v[36:39]
  v_cvt_pk_bf16_f32 v57, v54, v55
  v_lshlrev_b32 v54, 16, v57
  v_and_b32 v55, 0xffff0000, v57
  v_max3_f32 v60, v60, v54, v55
  v_cndmask_b32 v58, v32, v33, s[62:63]
  v_cndmask_b32 v59, v34, v35, s[62:63]
  v_cndmask_b32 v48, v58, v59, s[64:65]
  s_cbranch_vccnz ks_16
  s_waitcnt vmcnt(4)
  buffer_load_dwordx4 v[104:107], v3, s[40:43], s48 offen nt
  s_add_u32 s48, s48, 4096
ks_16:
  v_mfma_f32_16x16x32_bf16 v[36:39], v[108:111], v[28:31], v[36:39]
  v_max_f32_dpp v60, v60, v60 row_half_mirror row_mask:0xf bank_mask:0xf
  v_add_f32_dpp v48, v48, v48 quad_perm:[1,0,3,2] row_mask:0xf bank_mask:0xf
  s_cbranch_vccnz ks_17
  s_waitcnt vmcnt(4)
  buffer_load_dwordx4 v[108:111], v3, s[40:43], s48 offen nt
  s_add_u32 s48, s48, 36864
ks_17:
  v_mfma_f32_16x16x32_bf16 v[40:43], v[112:115], v[16:19], 0
  v_max_f32_dpp v60, v60, v60 row_mirror row_mask:0xf bank_mask:0xf
  v_add_f32_dpp v48, v48, v48 quad_perm:[2,3,0,1] row_mask:0xf bank_mask:0xf
  s_cbranch_vccnz ks_18
  s_waitcnt vmcnt(4)
  buffer_load_dwordx4 v[112:115], v3, s[40:43], s48 offen nt
  s_add_u32 s48, s48, 4096
ks_18:
  v_mfma_f32_16x16x32_bf16 v[40:43], v[116:119], v[20:23], v[40:43]
  v_max_f32_dpp v60, v60, v60 row_bcast:15 row_mask:0xa bank_mask:0xf
  s_nop 1
  v_max_f32_dpp v60, v60, v60 row_bcast:31 row_mask:0xc bank_mask:0xf
  s_cbranch_vccnz ks_19
  s_waitcnt vmcnt(4)
  buffer_load_dwordx4 v[116:119], v3, s[40:43], s48 offen nt
  s_add_u32 s48, s48, 4096
  s_branch kv_20
ks_19:
  s_waitcnt vmcnt(4)
  buffer_load_dwordx4 v[100:103], v2, s[44:47], s49 offen nt
  s_add_u32 s49, s49, 4096
kv_20:
  v_mfma_f32_16x16x32_bf16 v[40:43], v[120:123], v[24:27], v[40:43]
  v_readlane_b32 s57, v60, 63
  v_cndmask_b32 v58, v36, v37, s[62:63]
  v_cndmask_b32 v59, v38, v39, s[62:63]
  v_cndmask_b32 v49, v58, v59, s[64:65]
  s_cbranch_vccnz ks_21
  s_waitcnt vmcnt(4)
  buffer_load_dwordx4 v[120:123], v3, s[40:43], s48 offen nt
  s_add_u32 s48, s48, 4096
ks_21:
  v_mfma_f32_16x16x32_bf16 v[40:43], v[124:127], v[28:31], v[40:43]
  v_subrev_f32 v56, s57, v56
  v_subrev_f32 v52, s57, v52
  v_subrev_f32 v53, s57, v53
  v_subrev_f32 v54, s57, v54
  v_subrev_f32 v55, s57, v55
  v_add_f32_dpp v49, v49, v49 quad_perm:[1,0,3,2] row_mask:0xf bank_mask:0xf
  s_cbranch_vccnz ks_22
  s_waitcnt vmcnt(4)
  buffer_load_dwordx4 v[124:127], v3, s[40:43], s48 offen nt
  s_add_u32 s48, s48, 4096
ks_22:
  v_mfma_f32_16x16x32_bf16 v[44:47], v[128:131], v[16:19], 0
  v_mul_f32 v56, 0x3fb8aa3b, v56
  v_mul_f32 v52, 0x3fb8aa3b, v52
  v_mul_f32 v53, 0x3fb8aa3b, v53
  v_mul_f32 v54, 0x3fb8aa3b, v54
  v_mul_f32 v55, 0x3fb8aa3b, v55
  v_add_f32_dpp v49, v49, v49 quad_perm:[2,3,0,1] row_mask:0xf bank_mask:0xf
  s_cbranch_vccnz ks_23
  s_waitcnt vmcnt(4)
  buffer_load_dwordx4 v[128:131], v3, s[40:43], s48 offen nt
  s_add_u32 s48, s48, 4096
ks_23:
  v_mfma_f32_16x16x32_bf16 v[44:47], v[132:135], v[20:23], v[44:47]
  v_exp_f32 v56, v56
  v_exp_f32 v52, v52
  v_exp_f32 v53, v53
  v_exp_f32 v54, v54
  v_exp_f32 v55, v55
  s_cbranch_vccnz ks_24
  s_waitcnt vmcnt(4)
  buffer_load_dwordx4 v[132:135], v3, s[40:43], s48 offen nt
  s_add_u32 s48, s48, 4096
  s_branch kv_25
ks_24:
  s_waitcnt vmcnt(4)
  buffer_load_dwordx4 v[104:107], v2, s[44:47], s49 offen nt
  s_add_u32 s49, s49, 4096
kv_25:
  v_mfma_f32_16x16x32_bf16 v[44:47], v[136:139], v[24:27], v[44:47]
  v_fma_f32 v10, v10, v56, v52
  v_add_f32 v60, v53, v54
  v_add_f32 v10, v10, v55
  v_add_f32 v10, v10, v60
  ds_write_b32 v9, v56
  v_cndmask_b32 v58, v40, v41, s[62:63]
  v_cndmask_b32 v59, v42, v43, s[62:63]
  v_cndmask_b32 v50, v58, v59, s[64:65]
  s_cbranch_vccnz ks_26
  s_waitcnt vmcnt(4)
  buffer_load_dwordx4 v[136:139], v3, s[40:43], s48 offen nt
  s_add_u32 s48, s48, 4096
ks_26:
  v_mfma_f32_16x16x32_bf16 v[44:47], v[140:143], v[28:31], v[44:47]
  v_cvt_pk_bf16_f32 v52, v52, v52
  v_cvt_pk_bf16_f32 v53, v53, v53
  v_cvt_pk_bf16_f32 v54, v54, v54
  v_cvt_pk_bf16_f32 v55, v55, v55
  ds_write_b128 v8, v[52:55]
  v_add_u32 v9, 0x100, v9
  v_add_u32 v8, 0x400, v8
  v_add_f32_dpp v50, v50, v50 quad_perm:[1,0,3,2] row_mask:0xf bank_mask:0xf
  s_add_u32 s56, s56, 1
  s_cbranch_vccnz ks_27
  s_waitcnt vmcnt(4)
  buffer_load_dwordx4 v[140:143], v3, s[40:43], s48 offen nt
  s_add_u32 s48, s48, 36864
ks_27:
  v_mfma_f32_16x16x32_bf16 v[32:35], v[144:147], v[16:19], 0
  v_add_f32_dpp v50, v50, v50 quad_perm:[2,3,0,1] row_mask:0xf bank_mask:0xf
  v_cvt_pk_bf16_f32 v57, v48, v49
  v_lshlrev_b32 v52, 16, v57
  v_and_b32 v53, 0xffff0000, v57
  v_mul_f32 v52, s60, v52
  s_cbranch_vccnz ks_28
  s_waitcnt vmcnt(4)
  buffer_load_dwordx4 v[144:147], v3, s[40:43], s48 offen nt
  s_add_u32 s48, s48, 4096
ks_28:
  v_mfma_f32_16x16x32_bf16 v[32:35], v[148:151], v[20:23], v[32:35]
  v_mul_f32 v53, s60, v53
  v_cvt_pk_bf16_f32 v57, v52, v53
  v_lshlrev_b32 v52, 16, v57
  v_and_b32 v53, 0xffff0000, v57
  s_cbranch_vccnz ks_29
  s_waitcnt vmcnt(4)
  buffer_load_dwordx4 v[148:151], v3, s[40:43], s48 offen nt
  s_add_u32 s48, s48, 4096
  s_branch kv_30
ks_29:
  s_waitcnt vmcnt(4)
  buffer_load_dwordx4 v[108:111], v2, s[44:47], s49 offen nt
  s_add_u32 s49, s49, 36864
kv_30:
  v_mfma_f32_16x16x32_bf16 v[32:35], v[152:155], v[24:27], v[32:35]
  v_cndmask_b32 v58, v44, v45, s[62:63]
  v_cndmask_b32 v59, v46, v47, s[62:63]
  v_cndmask_b32 v51, v58, v59, s[64:65]
  s_cbranch_vccnz ks_31
  s_waitcnt vmcnt(4)
  buffer_load_dwordx4 v[152:155], v3, s[40:43], s48 offen nt
  s_add_u32 s48, s48, 4096
ks_31:
  v_mfma_f32_16x16x32_bf16 v[32:35], v[156:159], v[28:31], v[32:35]
  v_add_f32_dpp v51, v51, v51 quad_perm:[1,0,3,2] row_mask:0xf bank_mask:0xf
  v_max3_f32 v60, v52, v53, s57
  v_mov_b32 v56, s57
  s_cbranch_vccnz ks_32
  s_waitcnt vmcnt(4)
  buffer_load_dwordx4 v[156:159], v3, s[40:43], s48 offen nt
  s_add_u32 s48, s48, 4096
ks_32:
  v_mfma_f32_16x16x32_bf16 v[36:39], v[160:163], v[16:19], 0
  v_add_f32_dpp v51, v51, v51 quad_perm:[2,3,0,1] row_mask:0xf bank_mask:0xf
  s_cbranch_vccnz ks_33
  s_waitcnt vmcnt(4)
  buffer_load_dwordx4 v[160:163], v3, s[40:43], s48 offen nt
  s_add_u32 s48, s48, 4096
ks_33:
  v_mfma_f32_16x16x32_bf16 v[36:39], v[164:167], v[20:23], v[36:39]
  v_cvt_pk_bf16_f32 v57, v50, v51
  v_lshlrev_b32 v54, 16, v57
  v_and_b32 v55, 0xffff0000, v57
  v_mul_f32 v54, s60, v54
  v_mul_f32 v55, s60, v55
  s_cbranch_vccnz ks_34
  s_waitcnt vmcnt(4)
  buffer_load_dwordx4 v[164:167], v3, s[40:43], s48 offen nt
  s_add_u32 s48, s48, 4096
  s_branch kv_35
ks_34:
  s_waitcnt vmcnt(4)
  buffer_load_dwordx4 v[112:115], v2, s[44:47], s49 offen nt
  s_add_u32 s49, s49, 4096
kv_35:
  v_mfma_f32_16x16x32_bf16 v[36:39], v[168:171], v[24:27], v[36:39]
  v_cvt_pk_bf16_f32 v57, v54, v55
  v_lshlrev_b32 v54, 16, v57
  v_and_b32 v55, 0xffff0000, v57
  v_max3_f32 v60, v60, v54, v55
  v_cndmask_b32 v58, v32, v33, s[62:63]
  v_cndmask_b32 v59, v34, v35, s[62:63]
  v_cndmask_b32 v48, v58, v59, s[64:65]
  s_cbranch_vccnz ks_36
  s_waitcnt vmcnt(4)
  buffer_load_dwordx4 v[168:171], v3, s[40:43], s48 offen nt
  s_add_u32 s48, s48, 4096
ks_36:
  v_mfma_f32_16x16x32_bf16 v[36:39], v[172:175], v[28:31], v[36:39]
  v_max_f32_dpp v60, v60, v60 row_half_mirror row_mask:0xf bank_mask:0xf
  v_add_f32_dpp v48, v48, v48 quad_perm:[1,0,3,2] row_mask:0xf bank_mask:0xf
  s_cbranch_vccnz ks_37
  s_waitcnt vmcnt(4)
  buffer_load_dwordx4 v[172:175], v3, s[40:43], s48 offen nt
  s_add_u32 s48, s48, 36864
ks_37:
  v_mfma_f32_16x16x32_bf16 v[40:43], v[176:179], v[16:19], 0
  v_max_f32_dpp v60, v60, v60 row_mirror row_mask:0xf bank_mask:0xf
  v_add_f32_dpp v48, v48, v48 quad_perm:[2,3,0,1] row_mask:0xf bank_mask:0xf
  s_cbranch_vccnz ks_38
  s_waitcnt vmcnt(4)
  buffer_load_dwordx4 v[176:179], v3, s[40:43], s48 offen nt
  s_add_u32 s48, s48, 4096
ks_38:
  v_mfma_f32_16x16x32_bf16 v[40:43], v[180:183], v[20:23], v[40:43]
  v_max_f32_dpp v60, v60, v60 row_bcast:15 row_mask:0xa bank_mask:0xf
  s_nop 1
  v_max_f32_dpp v60, v60, v60 row_bcast:31 row_mask:0xc bank_mask:0xf
  s_cbranch_vccnz ks_39
  s_waitcnt vmcnt(4)
  buffer_load_dwordx4 v[180:183], v3, s[40:43], s48 offen nt
  s_add_u32 s48, s48, 4096
  s_branch kv_40
ks_39:
  s_waitcnt vmcnt(4)
  buffer_load_dwordx4 v[116:119], v2, s[44:47], s49 offen nt
  s_add_u32 s49, s49, 4096
kv_40:
  v_mfma_f32_16x16x32_bf16 v[40:43], v[184:187], v[24:27], v[40:43]
  v_readlane_b32 s57, v60, 63
  v_cndmask_b32 v58, v36, v37, s[62:63]
  v_cndmask_b32 v59, v38, v39, s[62:63]
  v_cndmask_b32 v49, v58, v59, s[64:65]
  s_cbranch_vccnz ks_41
  s_waitcnt vmcnt(4)
  buffer_load_dwordx4 v[184:187], v3, s[40:43], s48 offen nt
  s_add_u32 s48, s48, 4096
ks_41:
  v_mfma_f32_16x16x32_bf16 v[40:43], v[188:191], v[28:31], v[40:43]
  v_subrev_f32 v56, s57, v56
  v_subrev_f32 v52, s57, v52
  v_subrev_f32 v53, s57, v53
  v_subrev_f32 v54, s57, v54
  v_subrev_f32 v55, s57, v55
  v_add_f32_dpp v49, v49, v49 quad_perm:[1,0,3,2] row_mask:0xf bank_mask:0xf
  s_cbranch_vccnz ks_42
  s_waitcnt vmcnt(4)
  buffer_load_dwordx4 v[188:191], v3, s[40:43], s48 offen nt
  s_add_u32 s48, s48, 4096
ks_42:
  v_mfma_f32_16x16x32_bf16 v[44:47], v[192:195], v[16:19], 0
  v_mul_f32 v56, 0x3fb8aa3b, v56
  v_mul_f32 v52, 0x3fb8aa3b, v52
  v_mul_f32 v53, 0x3fb8aa3b, v53
  v_mul_f32 v54, 0x3fb8aa3b, v54
  v_mul_f32 v55, 0x3fb8aa3b, v55
  v_add_f32_dpp v49, v49, v49 quad_perm:[2,3,0,1] row_mask:0xf bank_mask:0xf
  s_cbranch_vccnz ks_43
  s_waitcnt vmcnt(4)
  buffer_load_dwordx4 v[192:195], v3, s[40:43], s48 offen nt
  s_add_u32 s48, s48, 4096
ks_43:
  v_mfma_f32_16x16x32_bf16 v[44:47], v[196:199], v[20:23], v[44:47]
  v_exp_f32 v56, v56
  v_exp_f32 v52, v52
  v_exp_f32 v53, v53
  v_exp_f32 v54, v54
  v_exp_f32 v55, v55
  s_cbranch_vccnz ks_44
  s_waitcnt vmcnt(4)
  buffer_load_dwordx4 v[196:199], v3, s[40:43], s48 offen nt
  s_add_u32 s48, s48, 4096
ks_44:
  v_mfma_f32_16x16x32_bf16 v[44:47], v[200:203], v[24:27], v[44:47]
  v_fma_f32 v10, v10, v56, v52
  v_add_f32 v60, v53, v54
  v_add_f32 v10, v10, v55
  v_add_f32 v10, v10, v60
  ds_write_b32 v9, v56
  v_cndmask_b32 v58, v40, v41, s[62:63]
  v_cndmask_b32 v59, v42, v43, s[62:63]
  v_cndmask_b32 v50, v58, v59, s[64:65]
  s_cbranch_vccnz ks_45
  s_waitcnt vmcnt(4)
  buffer_load_dwordx4 v[200:203], v3, s[40:43], s48 offen nt
  s_add_u32 s48, s48, 4096
ks_45:
  v_mfma_f32_16x16x32_bf16 v[44:47], v[204:207], v[28:31], v[44:47]
  v_cvt_pk_bf16_f32 v52, v52, v52
  v_cvt_pk_bf16_f32 v53, v53, v53
  v_cvt_pk_bf16_f32 v54, v54, v54
  v_cvt_pk_bf16_f32 v55, v55, v55
  ds_write_b128 v8, v[52:55]
  v_add_u32 v9, 0x100, v9
  v_add_u32 v8, 0x400, v8
  v_add_f32_dpp v50, v50, v50 quad_perm:[1,0,3,2] row_mask:0xf bank_mask:0xf
  s_add_u32 s56, s56, 1
  v_mov_b32 v72, s56
  ds_write_b32 v71, v72
  s_cmp_eq_u32 s56, 14
  s_cselect_b64 vcc, -1, 0
  s_cmp_lt_u32 s56, 16
  s_cbranch_scc1 L_kloop
L_kdone:
  v_add_f32_dpp v50, v50, v50 quad_perm:[2,3,0,1] row_mask:0xf bank_mask:0xf
  v_cvt_pk_bf16_f32 v57, v48, v49
  v_lshlrev_b32 v52, 16, v57
  v_and_b32 v53, 0xffff0000, v57
  v_mul_f32 v52, s60, v52
  v_mul_f32 v53, s60, v53
  v_cvt_pk_bf16_f32 v57, v52, v53
  v_lshlrev_b32 v52, 16, v57
  v_and_b32 v53, 0xffff0000, v57
  v_cndmask_b32 v58, v44, v45, s[62:63]
  v_cndmask_b32 v59, v46, v47, s[62:63]
  v_cndmask_b32 v51, v58, v59, s[64:65]
  s_nop 1
  v_add_f32_dpp v51, v51, v51 quad_perm:[1,0,3,2] row_mask:0xf bank_mask:0xf
  v_max3_f32 v60, v52, v53, s57
  v_mov_b32 v56, s57
  v_add_f32_dpp v51, v51, v51 quad_perm:[2,3,0,1] row_mask:0xf bank_mask:0xf
  v_cvt_pk_bf16_f32 v57, v50, v51
  v_lshlrev_b32 v54, 16, v57
  v_and_b32 v55, 0xffff0000, v57
  v_mul_f32 v54, s60, v54
  v_mul_f32 v55, s60, v55
  v_cvt_pk_bf16_f32 v57, v54, v55
  v_lshlrev_b32 v54, 16, v57
  v_and_b32 v55, 0xffff0000, v57
  v_max3_f32 v60, v60, v54, v55
  s_nop 1
  v_max_f32_dpp v60, v60, v60 row_half_mirror row_mask:0xf bank_mask:0xf
  s_nop 1
  v_max_f32_dpp v60, v60, v60 row_mirror row_mask:0xf bank_mask:0xf
  s_nop 1
  v_max_f32_dpp v60, v60, v60 row_bcast:15 row_mask:0xa bank_mask:0xf
  s_nop 1
  v_max_f32_dpp v60, v60, v60 row_bcast:31 row_mask:0xc bank_mask:0xf
  s_nop 0
  v_readlane_b32 s57, v60, 63
  s_nop 1
  v_subrev_f32 v56, s57, v56
  v_subrev_f32 v52, s57, v52
  v_subrev_f32 v53, s57, v53
  v_subrev_f32 v54, s57, v54
  v_subrev_f32 v55, s57, v55
  v_mul_f32 v56, 0x3fb8aa3b, v56
  v_mul_f32 v52, 0x3fb8aa3b, v52
  v_mul_f32 v53, 0x3fb8aa3b, v53
  v_mul_f32 v54, 0x3fb8aa3b, v54
  v_mul_f32 v55, 0x3fb8aa3b, v55
  v_exp_f32 v56, v56
  v_exp_f32 v52, v52
  v_exp_f32 v53, v53
  v_exp_f32 v54, v54
  v_exp_f32 v55, v55
  v_fma_f32 v10, v10, v56, v52
  v_add_f32 v60, v53, v54
  v_add_f32 v10, v10, v55
  v_add_f32 v10, v10, v60
  ds_write_b32 v9, v56
  v_cvt_pk_bf16_f32 v52, v52, v52
  v_cvt_pk_bf16_f32 v53, v53, v53
  v_cvt_pk_bf16_f32 v54, v54, v54
  v_cvt_pk_bf16_f32 v55, v55, v55
  ds_write_b128 v8, v[52:55]
  v_add_u32 v9, 0x100, v9
  v_add_u32 v8, 0x400, v8
  v_add_f32_dpp v10, v10, v10 row_half_mirror row_mask:0xf bank_mask:0xf
  s_nop 1
  v_add_f32_dpp v10, v10, v10 row_mirror row_mask:0xf bank_mask:0xf
  s_nop 1
  v_add_f32_dpp v10, v10, v10 row_bcast:15 row_mask:0xa bank_mask:0xf
  s_nop 1
  v_add_f32_dpp v10, v10, v10 row_bcast:31 row_mask:0xc bank_mask:0xf
  s_nop 0
  v_readlane_b32 s58, v10, 63
  v_mov_b32 v58, s57
  s_nop 0
  v_mov_b32 v59, s58
  s_lshl_b32 s58, s11, 3
  v_mov_b32 v11, s58
  ds_write_b64 v11, v[58:59] offset:6144
  v_mov_b32 v11, 1
  ds_add_u32 v71, v11 offset:4
  v_subrev_u32 v8, 0x4000, v8
  v_subrev_u32 v9, 0x1000, v9
  ds_read_b128 v[48:51], v8
  ds_read_b32 v57, v9
.p2align 6
L_vloop:
  s_waitcnt lgkmcnt(0)
  v_mov_b32 v52, v48
  v_mov_b32 v53, v49
  v_mov_b32 v54, v50
  v_mov_b32 v55, v51
  v_mov_b32 v56, v57
  ds_read_b128 v[48:51], v8 offset:1024
  ds_read_b32 v57, v9 offset:256
  ds_read_b32 v74, v71 offset:16
  v_add_u32 v8, 0x400, v8
  v_add_u32 v9, 0x100, v9
  v_and_b32_dpp v60, v52, v4 row_newbcast:0 row_mask:0xf bank_mask:0xf
  v_and_b32_dpp v61, v52, v5 row_newbcast:0 row_mask:0xf bank_mask:0xf
  v_and_b32_dpp v62, v52, v6 row_newbcast:0 row_mask:0xf bank_mask:0xf
  v_and_b32_dpp v63, v52, v7 row_newbcast:0 row_mask:0xf bank_mask:0xf
  v_mul_f32 v12, v56, v12
  v_mul_f32 v13, v56, v13
  v_mul_f32 v14, v56, v14
  v_mul_f32 v15, v56, v15
  s_waitcnt vmcnt(4)
  buffer_load_dwordx4 v[120:123], v2, s[44:47], s49 offen nt
  s_add_u32 s49, s49, 4096
  v_and_b32_dpp v64, v52, v4 row_newbcast:4 row_mask:0xf bank_mask:0xf
  v_and_b32_dpp v65, v52, v5 row_newbcast:4 row_mask:0xf bank_mask:0xf
  v_and_b32_dpp v66, v52, v6 row_newbcast:4 row_mask:0xf bank_mask:0xf
  v_and_b32_dpp v67, v52, v7 row_newbcast:4 row_mask:0xf bank_mask:0xf
  v_mfma_f32_16x16x32_bf16 v[12:15], v[60:63], v[80:83], v[12:15]
  s_waitcnt vmcnt(4)
  buffer_load_dwordx4 v[124:127], v2, s[44:47], s49 offen nt
  s_add_u32 s49, s49, 4096
  v_and_b32_dpp v60, v52, v4 row_newbcast:8 row_mask:0xf bank_mask:0xf
  v_and_b32_dpp v61, v52, v5 row_newbcast:8 row_mask:0xf bank_mask:0xf
  v_and_b32_dpp v62, v52, v6 row_newbcast:8 row_mask:0xf bank_mask:0xf
  v_and_b32_dpp v63, v52, v7 row_newbcast:8 row_mask:0xf bank_mask:0xf
  v_mfma_f32_16x16x32_bf16 v[12:15], v[64:67], v[84:87], v[12:15]
  s_waitcnt vmcnt(4)
  buffer_load_dwordx4 v[128:131], v2, s[44:47], s49 offen nt
  s_add_u32 s49, s49, 4096
  v_and_b32_dpp v64, v52, v4 row_newbcast:12 row_mask:0xf bank_mask:0xf
  v_and_b32_dpp v65, v52, v5 row_newbcast:12 row_mask:0xf bank_mask:0xf
  v_and_b32_dpp v66, v52, v6 row_newbcast:12 row_mask:0xf bank_mask:0xf
  v_and_b32_dpp v67, v52, v7 row_newbcast:12 row_mask:0xf bank_mask:0xf
  v_mfma_f32_16x16x32_bf16 v[12:15], v[60:63], v[88:91], v[12:15]
  s_waitcnt vmcnt(4)
  buffer_load_dwordx4 v[132:135], v2, s[44:47], s49 offen nt
  s_add_u32 s49, s49, 4096
  v_and_b32_dpp v60, v53, v4 row_newbcast:0 row_mask:0xf bank_mask:0xf
  v_and_b32_dpp v61, v53, v5 row_newbcast:0 row_mask:0xf bank_mask:0xf
  v_and_b32_dpp v62, v53, v6 row_newbcast:0 row_mask:0xf bank_mask:0xf
  v_and_b32_dpp v63, v53, v7 row_newbcast:0 row_mask:0xf bank_mask:0xf
  v_mfma_f32_16x16x32_bf16 v[12:15], v[64:67], v[92:95], v[12:15]
  s_waitcnt vmcnt(4)
  buffer_load_dwordx4 v[136:139], v2, s[44:47], s49 offen nt
  s_add_u32 s49, s49, 4096
  v_and_b32_dpp v64, v53, v4 row_newbcast:4 row_mask:0xf bank_mask:0xf
  v_and_b32_dpp v65, v53, v5 row_newbcast:4 row_mask:0xf bank_mask:0xf
  v_and_b32_dpp v66, v53, v6 row_newbcast:4 row_mask:0xf bank_mask:0xf
  v_and_b32_dpp v67, v53, v7 row_newbcast:4 row_mask:0xf bank_mask:0xf
  v_mfma_f32_16x16x32_bf16 v[12:15], v[60:63], v[96:99], v[12:15]
  s_waitcnt vmcnt(4)
  buffer_load_dwordx4 v[140:143], v2, s[44:47], s49 offen nt
  s_add_u32 s49, s49, 36864
  v_and_b32_dpp v60, v53, v4 row_newbcast:8 row_mask:0xf bank_mask:0xf
  v_and_b32_dpp v61, v53, v5 row_newbcast:8 row_mask:0xf bank_mask:0xf
  v_and_b32_dpp v62, v53, v6 row_newbcast:8 row_mask:0xf bank_mask:0xf
  v_and_b32_dpp v63, v53, v7 row_newbcast:8 row_mask:0xf bank_mask:0xf
  v_mfma_f32_16x16x32_bf16 v[12:15], v[64:67], v[100:103], v[12:15]
  s_waitcnt vmcnt(4)
  buffer_load_dwordx4 v[80:83], v2, s[44:47], s49 offen nt
  s_add_u32 s49, s49, 4096
  v_and_b32_dpp v64, v53, v4 row_newbcast:12 row_mask:0xf bank_mask:0xf
  v_and_b32_dpp v65, v53, v5 row_newbcast:12 row_mask:0xf bank_mask:0xf
  v_and_b32_dpp v66, v53, v6 row_newbcast:12 row_mask:0xf bank_mask:0xf
  v_and_b32_dpp v67, v53, v7 row_newbcast:12 row_mask:0xf bank_mask:0xf
  v_mfma_f32_16x16x32_bf16 v[12:15], v[60:63], v[104:107], v[12:15]
  s_waitcnt vmcnt(4)
  buffer_load_dwordx4 v[84:87], v2, s[44:47], s49 offen nt
  s_add_u32 s49, s49, 4096
  v_and_b32_dpp v60, v54, v4 row_newbcast:0 row_mask:0xf bank_mask:0xf
  v_and_b32_dpp v61, v54, v5 row_newbcast:0 row_mask:0xf bank_mask:0xf
  v_and_b32_dpp v62, v54, v6 row_newbcast:0 row_mask:0xf bank_mask:0xf
  v_and_b32_dpp v63, v54, v7 row_newbcast:0 row_mask:0xf bank_mask:0xf
  v_mfma_f32_16x16x32_bf16 v[12:15], v[64:67], v[108:111], v[12:15]
  s_waitcnt vmcnt(4)
  buffer_load_dwordx4 v[88:91], v2, s[44:47], s49 offen nt
  s_add_u32 s49, s49, 4096
  v_and_b32_dpp v64, v54, v4 row_newbcast:4 row_mask:0xf bank_mask:0xf
  v_and_b32_dpp v65, v54, v5 row_newbcast:4 row_mask:0xf bank_mask:0xf
  v_and_b32_dpp v66, v54, v6 row_newbcast:4 row_mask:0xf bank_mask:0xf
  v_and_b32_dpp v67, v54, v7 row_newbcast:4 row_mask:0xf bank_mask:0xf
  v_mfma_f32_16x16x32_bf16 v[12:15], v[60:63], v[112:115], v[12:15]
  s_waitcnt vmcnt(4)
  buffer_load_dwordx4 v[92:95], v2, s[44:47], s49 offen nt
  s_add_u32 s49, s49, 4096
  v_and_b32_dpp v60, v54, v4 row_newbcast:8 row_mask:0xf bank_mask:0xf
  v_and_b32_dpp v61, v54, v5 row_newbcast:8 row_mask:0xf bank_mask:0xf
  v_and_b32_dpp v62, v54, v6 row_newbcast:8 row_mask:0xf bank_mask:0xf
  v_and_b32_dpp v63, v54, v7 row_newbcast:8 row_mask:0xf bank_mask:0xf
  v_mfma_f32_16x16x32_bf16 v[12:15], v[64:67], v[116:119], v[12:15]
  s_waitcnt vmcnt(4)
  buffer_load_dwordx4 v[96:99], v2, s[44:47], s49 offen nt
  s_add_u32 s49, s49, 4096
  v_and_b32_dpp v64, v54, v4 row_newbcast:12 row_mask:0xf bank_mask:0xf
  v_and_b32_dpp v65, v54, v5 row_newbcast:12 row_mask:0xf bank_mask:0xf
  v_and_b32_dpp v66, v54, v6 row_newbcast:12 row_mask:0xf bank_mask:0xf
  v_and_b32_dpp v67, v54, v7 row_newbcast:12 row_mask:0xf bank_mask:0xf
  v_mfma_f32_16x16x32_bf16 v[12:15], v[60:63], v[120:123], v[12:15]
  s_waitcnt vmcnt(4)
  buffer_load_dwordx4 v[100:103], v2, s[44:47], s49 offen nt
  s_add_u32 s49, s49, 4096
  v_and_b32_dpp v60, v55, v4 row_newbcast:0 row_mask:0xf bank_mask:0xf
  v_and_b32_dpp v61, v55, v5 row_newbcast:0 row_mask:0xf bank_mask:0xf
  v_and_b32_dpp v62, v55, v6 row_newbcast:0 row_mask:0xf bank_mask:0xf
  v_and_b32_dpp v63, v55, v7 row_newbcast:0 row_mask:0xf bank_mask:0xf
  v_mfma_f32_16x16x32_bf16 v[12:15], v[64:67], v[124:127], v[12:15]
  s_waitcnt vmcnt(4)
  buffer_load_dwordx4 v[104:107], v2, s[44:47], s49 offen nt
  s_add_u32 s49, s49, 4096
  v_and_b32_dpp v64, v55, v4 row_newbcast:4 row_mask:0xf bank_mask:0xf
  v_and_b32_dpp v65, v55, v5 row_newbcast:4 row_mask:0xf bank_mask:0xf
  v_and_b32_dpp v66, v55, v6 row_newbcast:4 row_mask:0xf bank_mask:0xf
  v_and_b32_dpp v67, v55, v7 row_newbcast:4 row_mask:0xf bank_mask:0xf
  v_mfma_f32_16x16x32_bf16 v[12:15], v[60:63], v[128:131], v[12:15]
  s_waitcnt vmcnt(4)
  buffer_load_dwordx4 v[108:111], v2, s[44:47], s49 offen nt
  s_add_u32 s49, s49, 36864
  v_and_b32_dpp v60, v55, v4 row_newbcast:8 row_mask:0xf bank_mask:0xf
  v_and_b32_dpp v61, v55, v5 row_newbcast:8 row_mask:0xf bank_mask:0xf
  v_and_b32_dpp v62, v55, v6 row_newbcast:8 row_mask:0xf bank_mask:0xf
  v_and_b32_dpp v63, v55, v7 row_newbcast:8 row_mask:0xf bank_mask:0xf
  v_mfma_f32_16x16x32_bf16 v[12:15], v[64:67], v[132:135], v[12:15]
  s_waitcnt vmcnt(4)
  buffer_load_dwordx4 v[112:115], v2, s[44:47], s49 offen nt
  s_add_u32 s49, s49, 4096
  v_and_b32_dpp v64, v55, v4 row_newbcast:12 row_mask:0xf bank_mask:0xf
  v_and_b32_dpp v65, v55, v5 row_newbcast:12 row_mask:0xf bank_mask:0xf
  v_and_b32_dpp v66, v55, v6 row_newbcast:12 row_mask:0xf bank_mask:0xf
  v_and_b32_dpp v67, v55, v7 row_newbcast:12 row_mask:0xf bank_mask:0xf
  v_mfma_f32_16x16x32_bf16 v[12:15], v[60:63], v[136:139], v[12:15]
  s_waitcnt vmcnt(4)
  buffer_load_dwordx4 v[116:119], v2, s[44:47], s49 offen nt
  s_add_u32 s49, s49, 4096
  v_mfma_f32_16x16x32_bf16 v[12:15], v[64:67], v[140:143], v[12:15]
  s_add_u32 s56, s56, 1
  s_waitcnt lgkmcnt(0)
  v_readfirstlane_b32 s59, v74
  v_mov_b32 v72, s56
  ds_write_b32 v71, v72
  s_lshr_b32 s58, s59, 8
  s_and_b32 s59, s59, 0xff
  s_min_u32 s58, s58, 30
  s_cmp_lt_u32 s56, s58
  s_cbranch_scc1 L_vloop4
  s_min_u32 s59, s59, 30
  s_cmp_lt_u32 s56, s59
  s_cbranch_scc1 L_vloop3
  s_cmp_lt_u32 s56, 30
  s_cbranch_scc1 L_vloop
.p2align 6
L_vloop2:
  s_waitcnt lgkmcnt(0)
  v_mov_b32 v52, v48
  v_mov_b32 v53, v49
  v_mov_b32 v54, v50
  v_mov_b32 v55, v51
  v_mov_b32 v56, v57
  ds_read_b128 v[48:51], v8 offset:1024
  ds_read_b32 v57, v9 offset:256
  ds_read_b32 v74, v71 offset:16
  v_add_u32 v8, 0x400, v8
  v_add_u32 v9, 0x100, v9
  v_and_b32_dpp v60, v52, v4 row_newbcast:0 row_mask:0xf bank_mask:0xf
  v_and_b32_dpp v61, v52, v5 row_newbcast:0 row_mask:0xf bank_mask:0xf
  v_and_b32_dpp v62, v52, v6 row_newbcast:0 row_mask:0xf bank_mask:0xf
  v_and_b32_dpp v63, v52, v7 row_newbcast:0 row_mask:0xf bank_mask:0xf
  v_mul_f32 v12, v56, v12
  v_mul_f32 v13, v56, v13
  v_mul_f32 v14, v56, v14
  v_mul_f32 v15, v56, v15
  s_cmp_eq_u32 s56, 31
  s_cselect_b64 vcc, -1, 0
  s_waitcnt vmcnt(9)
  buffer_load_dwordx4 v[120:123], v2, s[44:47], s49 offen nt
  s_add_u32 s49, s49, 4096
  v_and_b32_dpp v64, v52, v4 row_newbcast:4 row_mask:0xf bank_mask:0xf
  v_and_b32_dpp v65, v52, v5 row_newbcast:4 row_mask:0xf bank_mask:0xf
  v_and_b32_dpp v66, v52, v6 row_newbcast:4 row_mask:0xf bank_mask:0xf
  v_and_b32_dpp v67, v52, v7 row_newbcast:4 row_mask:0xf bank_mask:0xf
  v_mfma_f32_16x16x32_bf16 v[12:15], v[60:63], v[80:83], v[12:15]
  s_waitcnt vmcnt(9)
  buffer_load_dwordx4 v[124:127], v2, s[44:47], s49 offen nt
  s_add_u32 s49, s49, 4096
  v_and_b32_dpp v60, v52, v4 row_newbcast:8 row_mask:0xf bank_mask:0xf
  v_and_b32_dpp v61, v52, v5 row_newbcast:8 row_mask:0xf bank_mask:0xf
  v_and_b32_dpp v62, v52, v6 row_newbcast:8 row_mask:0xf bank_mask:0xf
  v_and_b32_dpp v63, v52, v7 row_newbcast:8 row_mask:0xf bank_mask:0xf
  v_mfma_f32_16x16x32_bf16 v[12:15], v[64:67], v[84:87], v[12:15]
  s_waitcnt vmcnt(9)
  buffer_load_dwordx4 v[128:131], v2, s[44:47], s49 offen nt
  s_add_u32 s49, s49, 4096
  v_and_b32_dpp v64, v52, v4 row_newbcast:12 row_mask:0xf bank_mask:0xf
  v_and_b32_dpp v65, v52, v5 row_newbcast:12 row_mask:0xf bank_mask:0xf
  v_and_b32_dpp v66, v52, v6 row_newbcast:12 row_mask:0xf bank_mask:0xf
  v_and_b32_dpp v67, v52, v7 row_newbcast:12 row_mask:0xf bank_mask:0xf
  v_mfma_f32_16x16x32_bf16 v[12:15], v[60:63], v[88:91], v[12:15]
  s_waitcnt vmcnt(9)
  buffer_load_dwordx4 v[132:135], v2, s[44:47], s49 offen nt
  s_add_u32 s49, s49, 4096
  v_and_b32_dpp v60, v53, v4 row_newbcast:0 row_mask:0xf bank_mask:0xf
  v_and_b32_dpp v61, v53, v5 row_newbcast:0 row_mask:0xf bank_mask:0xf
  v_and_b32_dpp v62, v53, v6 row_newbcast:0 row_mask:0xf bank_mask:0xf
  v_and_b32_dpp v63, v53, v7 row_newbcast:0 row_mask:0xf bank_mask:0xf
  v_mfma_f32_16x16x32_bf16 v[12:15], v[64:67], v[92:95], v[12:15]
  s_waitcnt vmcnt(9)
  buffer_load_dwordx4 v[136:139], v2, s[44:47], s49 offen nt
  s_add_u32 s49, s49, 4096
  v_and_b32_dpp v64, v53, v4 row_newbcast:4 row_mask:0xf bank_mask:0xf
  v_and_b32_dpp v65, v53, v5 row_newbcast:4 row_mask:0xf bank_mask:0xf
  v_and_b32_dpp v66, v53, v6 row_newbcast:4 row_mask:0xf bank_mask:0xf
  v_and_b32_dpp v67, v53, v7 row_newbcast:4 row_mask:0xf bank_mask:0xf
  v_mfma_f32_16x16x32_bf16 v[12:15], v[60:63], v[96:99], v[12:15]
  s_waitcnt vmcnt(9)
  buffer_load_dwordx4 v[140:143], v2, s[44:47], s49 offen nt
  s_add_u32 s49, s49, 36864
  v_and_b32_dpp v60, v53, v4 row_newbcast:8 row_mask:0xf bank_mask:0xf
  v_and_b32_dpp v61, v53, v5 row_newbcast:8 row_mask:0xf bank_mask:0xf
  v_and_b32_dpp v62, v53, v6 row_newbcast:8 row_mask:0xf bank_mask:0xf
  v_and_b32_dpp v63, v53, v7 row_newbcast:8 row_mask:0xf bank_mask:0xf
  v_mfma_f32_16x16x32_bf16 v[12:15], v[64:67], v[100:103], v[12:15]
  s_cbranch_vccz vl_46
  s_waitcnt vmcnt(9)
  s_branch vm_47
vl_46:
  s_waitcnt vmcnt(9)
  buffer_load_dwordx4 v[80:83], v2, s[44:47], s49 offen nt
  s_add_u32 s49, s49, 4096
vm_47:
  v_and_b32_dpp v64, v53, v4 row_newbcast:12 row_mask:0xf bank_mask:0xf
  v_and_b32_dpp v65, v53, v5 row_newbcast:12 row_mask:0xf bank_mask:0xf
  v_and_b32_dpp v66, v53, v6 row_newbcast:12 row_mask:0xf bank_mask:0xf
  v_and_b32_dpp v67, v53, v7 row_newbcast:12 row_mask:0xf bank_mask:0xf
  v_mfma_f32_16x16x32_bf16 v[12:15], v[60:63], v[104:107], v[12:15]
  s_cbranch_vccz vl_48
  s_waitcnt vmcnt(8)
  s_branch vm_49
vl_48:
  s_waitcnt vmcnt(9)
  buffer_load_dwordx4 v[84:87], v2, s[44:47], s49 offen nt
  s_add_u32 s49, s49, 4096
vm_49:
  v_and_b32_dpp v60, v54, v4 row_newbcast:0 row_mask:0xf bank_mask:0xf
  v_and_b32_dpp v61, v54, v5 row_newbcast:0 row_mask:0xf bank_mask:0xf
  v_and_b32_dpp v62, v54, v6 row_newbcast:0 row_mask:0xf bank_mask:0xf
  v_and_b32_dpp v63, v54, v7 row_newbcast:0 row_mask:0xf bank_mask:0xf
  v_mfma_f32_16x16x32_bf16 v[12:15], v[64:67], v[108:111], v[12:15]
  s_cbranch_vccz vl_50
  s_waitcnt vmcnt(7)
  s_branch vm_51
vl_50:
  s_waitcnt vmcnt(9)
  buffer_load_dwordx4 v[88:91], v2, s[44:47], s49 offen nt
  s_add_u32 s49, s49, 4096
vm_51:
  v_and_b32_dpp v64, v54, v4 row_newbcast:4 row_mask:0xf bank_mask:0xf
  v_and_b32_dpp v65, v54, v5 row_newbcast:4 row_mask:0xf bank_mask:0xf
  v_and_b32_dpp v66, v54, v6 row_newbcast:4 row_mask:0xf bank_mask:0xf
  v_and_b32_dpp v67, v54, v7 row_newbcast:4 row_mask:0xf bank_mask:0xf
  v_mfma_f32_16x16x32_bf16 v[12:15], v[60:63], v[112:115], v[12:15]
  s_cbranch_vccz vl_52
  s_waitcnt vmcnt(6)
  s_branch vm_53
vl_52:
  s_waitcnt vmcnt(9)
  buffer_load_dwordx4 v[92:95], v2, s[44:47], s49 offen nt
  s_add_u32 s49, s49, 4096
vm_53:
  v_and_b32_dpp v60, v54, v4 row_newbcast:8 row_mask:0xf bank_mask:0xf
  v_and_b32_dpp v61, v54, v5 row_newbcast:8 row_mask:0xf bank_mask:0xf
  v_and_b32_dpp v62, v54, v6 row_newbcast:8 row_mask:0xf bank_mask:0xf
  v_and_b32_dpp v63, v54, v7 row_newbcast:8 row_mask:0xf bank_mask:0xf
  v_mfma_f32_16x16x32_bf16 v[12:15], v[64:67], v[116:119], v[12:15]
  s_cbranch_vccz vl_54
  s_waitcnt vmcnt(5)
  s_branch vm_55
vl_54:
  s_waitcnt vmcnt(9)
  buffer_load_dwordx4 v[96:99], v2, s[44:47], s49 offen nt
  s_add_u32 s49, s49, 4096
vm_55:
  v_and_b32_dpp v64, v54, v4 row_newbcast:12 row_mask:0xf bank_mask:0xf
  v_and_b32_dpp v65, v54, v5 row_newbcast:12 row_mask:0xf bank_mask:0xf
  v_and_b32_dpp v66, v54, v6 row_newbcast:12 row_mask:0xf bank_mask:0xf
  v_and_b32_dpp v67, v54, v7 row_newbcast:12 row_mask:0xf bank_mask:0xf
  v_mfma_f32_16x16x32_bf16 v[12:15], v[60:63], v[120:123], v[12:15]
  s_cbranch_vccz vl_56
  s_waitcnt vmcnt(4)
  s_branch vm_57
vl_56:
  s_waitcnt vmcnt(9)
  buffer_load_dwordx4 v[100:103], v2, s[44:47], s49 offen nt
  s_add_u32 s49, s49, 4096
vm_57:
  v_and_b32_dpp v60, v55, v4 row_newbcast:0 row_mask:0xf bank_mask:0xf
  v_and_b32_dpp v61, v55, v5 row_newbcast:0 row_mask:0xf bank_mask:0xf
  v_and_b32_dpp v62, v55, v6 row_newbcast:0 row_mask:0xf bank_mask:0xf
  v_and_b32_dpp v63, v55, v7 row_newbcast:0 row_mask:0xf bank_mask:0xf
  v_mfma_f32_16x16x32_bf16 v[12:15], v[64:67], v[124:127], v[12:15]
  s_cbranch_vccz vl_58
  s_waitcnt vmcnt(3)
  s_branch vm_59
vl_58:
  s_waitcnt vmcnt(9)
  buffer_load_dwordx4 v[104:107], v2, s[44:47], s49 offen nt
  s_add_u32 s49, s49, 4096
vm_59:
  v_and_b32_dpp v64, v55, v4 row_newbcast:4 row_mask:0xf bank_mask:0xf
  v_and_b32_dpp v65, v55, v5 row_newbcast:4 row_mask:0xf bank_mask:0xf
  v_and_b32_dpp v66, v55, v6 row_newbcast:4 row_mask:0xf bank_mask:0xf
  v_and_b32_dpp v67, v55, v7 row_newbcast:4 row_mask:0xf bank_mask:0xf
  v_mfma_f32_16x16x32_bf16 v[12:15], v[60:63], v[128:131], v[12:15]
  s_cbranch_vccz vl_60
  s_waitcnt vmcnt(2)
  s_branch vm_61
vl_60:
  s_waitcnt vmcnt(9)
  buffer_load_dwordx4 v[108:111], v2, s[44:47], s49 offen nt
  s_add_u32 s49, s49, 36864
vm_61:
  v_and_b32_dpp v60, v55, v4 row_newbcast:8 row_mask:0xf bank_mask:0xf
  v_and_b32_dpp v61, v55, v5 row_newbcast:8 row_mask:0xf bank_mask:0xf
  v_and_b32_dpp v62, v55, v6 row_newbcast:8 row_mask:0xf bank_mask:0xf
  v_and_b32_dpp v63, v55, v7 row_newbcast:8 row_mask:0xf bank_mask:0xf
  v_mfma_f32_16x16x32_bf16 v[12:15], v[64:67], v[132:135], v[12:15]
  s_cbranch_vccz vl_62
  s_waitcnt vmcnt(1)
  s_branch vm_63
vl_62:
  s_waitcnt vmcnt(9)
  buffer_load_dwordx4 v[112:115], v2, s[44:47], s49 offen nt
  s_add_u32 s49, s49, 4096
vm_63:
  v_and_b32_dpp v64, v55, v4 row_newbcast:12 row_mask:0xf bank_mask:0xf
  v_and_b32_dpp v65, v55, v5 row_newbcast:12 row_mask:0xf bank_mask:0xf
  v_and_b32_dpp v66, v55, v6 row_newbcast:12 row_mask:0xf bank_mask:0xf
  v_and_b32_dpp v67, v55, v7 row_newbcast:12 row_mask:0xf bank_mask:0xf
  v_mfma_f32_16x16x32_bf16 v[12:15], v[60:63], v[136:139], v[12:15]
  s_cbranch_vccz vl_64
  s_waitcnt vmcnt(0)
  s_branch vm_65
vl_64:
  s_waitcnt vmcnt(9)
  buffer_load_dwordx4 v[116:119], v2, s[44:47], s49 offen nt
  s_add_u32 s49, s49, 4096
vm_65:
  v_mfma_f32_16x16x32_bf16 v[12:15], v[64:67], v[140:143], v[12:15]
  s_add_u32 s56, s56, 1
  s_waitcnt lgkmcnt(0)
  v_readfirstlane_b32 s59, v74
  v_mov_b32 v72, s56
  ds_write_b32 v71, v72
  s_cmp_lt_u32 s56, 32
  s_cbranch_scc1 L_vloop2
  s_nop 0
  v_cvt_pk_bf16_f32 v58, v12, v13
  v_cvt_pk_bf16_f32 v59, v14, v15
  s_mov_b32 exec_hi, 0
  ds_write_b16 v70, v58 offset:6656
  ds_write_b16_d16_hi v70, v58 offset:6672
  ds_write_b16 v70, v59 offset:6688
  ds_write_b16_d16_hi v70, v59 offset:6704
  s_waitcnt lgkmcnt(0)
  s_barrier
  s_endpgm
.p2align 6
L_vloop3:
  s_waitcnt lgkmcnt(0)
  v_mov_b32 v52, v48
  v_mov_b32 v53, v49
  v_mov_b32 v54, v50
  v_mov_b32 v55, v51
  v_mov_b32 v56, v57
  ds_read_b128 v[48:51], v8 offset:1024
  ds_read_b32 v57, v9 offset:256
  ds_read_b32 v74, v71 offset:16
  v_add_u32 v8, 0x400, v8
  v_add_u32 v9, 0x100, v9
  v_and_b32_dpp v60, v52, v4 row_newbcast:0 row_mask:0xf bank_mask:0xf
  v_and_b32_dpp v61, v52, v5 row_newbcast:0 row_mask:0xf bank_mask:0xf
  v_and_b32_dpp v62, v52, v6 row_newbcast:0 row_mask:0xf bank_mask:0xf
  v_and_b32_dpp v63, v52, v7 row_newbcast:0 row_mask:0xf bank_mask:0xf
  v_mul_f32 v12, v56, v12
  v_mul_f32 v13, v56, v13
  v_mul_f32 v14, v56, v14
  v_mul_f32 v15, v56, v15
  s_waitcnt vmcnt(3)
  buffer_load_dwordx4 v[120:123], v2, s[44:47], s49 offen nt
  s_add_u32 s49, s49, 4096
  v_and_b32_dpp v64, v52, v4 row_newbcast:4 row_mask:0xf bank_mask:0xf
  v_and_b32_dpp v65, v52, v5 row_newbcast:4 row_mask:0xf bank_mask:0xf
  v_and_b32_dpp v66, v52, v6 row_newbcast:4 row_mask:0xf bank_mask:0xf
  v_and_b32_dpp v67, v52, v7 row_newbcast:4 row_mask:0xf bank_mask:0xf
  v_mfma_f32_16x16x32_bf16 v[12:15], v[60:63], v[80:83], v[12:15]
  s_waitcnt vmcnt(3)
  buffer_load_dwordx4 v[124:127], v2, s[44:47], s49 offen nt
  s_add_u32 s49, s49, 4096
  v_and_b32_dpp v60, v52, v4 row_newbcast:8 row_mask:0xf bank_mask:0xf
  v_and_b32_dpp v61, v52, v5 row_newbcast:8 row_mask:0xf bank_mask:0xf
  v_and_b32_dpp v62, v52, v6 row_newbcast:8 row_mask:0xf bank_mask:0xf
  v_and_b32_dpp v63, v52, v7 row_newbcast:8 row_mask:0xf bank_mask:0xf
  v_mfma_f32_16x16x32_bf16 v[12:15], v[64:67], v[84:87], v[12:15]
  s_waitcnt vmcnt(3)
  buffer_load_dwordx4 v[128:131], v2, s[44:47], s49 offen nt
  s_add_u32 s49, s49, 4096
  v_and_b32_dpp v64, v52, v4 row_newbcast:12 row_mask:0xf bank_mask:0xf
  v_and_b32_dpp v65, v52, v5 row_newbcast:12 row_mask:0xf bank_mask:0xf
  v_and_b32_dpp v66, v52, v6 row_newbcast:12 row_mask:0xf bank_mask:0xf
  v_and_b32_dpp v67, v52, v7 row_newbcast:12 row_mask:0xf bank_mask:0xf
  v_mfma_f32_16x16x32_bf16 v[12:15], v[60:63], v[88:91], v[12:15]
  s_waitcnt vmcnt(3)
  buffer_load_dwordx4 v[132:135], v2, s[44:47], s49 offen nt
  s_add_u32 s49, s49, 4096
  v_and_b32_dpp v60, v53, v4 row_newbcast:0 row_mask:0xf bank_mask:0xf
  v_and_b32_dpp v61, v53, v5 row_newbcast:0 row_mask:0xf bank_mask:0xf
  v_and_b32_dpp v62, v53, v6 row_newbcast:0 row_mask:0xf bank_mask:0xf
  v_and_b32_dpp v63, v53, v7 row_newbcast:0 row_mask:0xf bank_mask:0xf
  v_mfma_f32_16x16x32_bf16 v[12:15], v[64:67], v[92:95], v[12:15]
  s_waitcnt vmcnt(4)
  buffer_load_dwordx4 v[136:139], v2, s[44:47], s49 offen nt
  s_add_u32 s49, s49, 4096
  v_and_b32_dpp v64, v53, v4 row_newbcast:4 row_mask:0xf bank_mask:0xf
  v_and_b32_dpp v65, v53, v5 row_newbcast:4 row_mask:0xf bank_mask:0xf
  v_and_b32_dpp v66, v53, v6 row_newbcast:4 row_mask:0xf bank_mask:0xf
  v_and_b32_dpp v67, v53, v7 row_newbcast:4 row_mask:0xf bank_mask:0xf
  v_mfma_f32_16x16x32_bf16 v[12:15], v[60:63], v[96:99], v[12:15]
  s_waitcnt vmcnt(4)
  buffer_load_dwordx4 v[140:143], v2, s[44:47], s49 offen nt
  s_add_u32 s49, s49, 36864
  v_and_b32_dpp v60, v53, v4 row_newbcast:8 row_mask:0xf bank_mask:0xf
  v_and_b32_dpp v61, v53, v5 row_newbcast:8 row_mask:0xf bank_mask:0xf
  v_and_b32_dpp v62, v53, v6 row_newbcast:8 row_mask:0xf bank_mask:0xf
  v_and_b32_dpp v63, v53, v7 row_newbcast:8 row_mask:0xf bank_mask:0xf
  v_mfma_f32_16x16x32_bf16 v[12:15], v[64:67], v[100:103], v[12:15]
  s_waitcnt vmcnt(4)
  buffer_load_dwordx4 v[80:83], v2, s[44:47], s49 offen nt
  s_add_u32 s49, s49, 4096
  v_and_b32_dpp v64, v53, v4 row_newbcast:12 row_mask:0xf bank_mask:0xf
  v_and_b32_dpp v65, v53, v5 row_newbcast:12 row_mask:0xf bank_mask:0xf
  v_and_b32_dpp v66, v53, v6 row_newbcast:12 row_mask:0xf bank_mask:0xf
  v_and_b32_dpp v67, v53, v7 row_newbcast:12 row_mask:0xf bank_mask:0xf
  v_mfma_f32_16x16x32_bf16 v[12:15], v[60:63], v[104:107], v[12:15]
  s_waitcnt vmcnt(4)
  buffer_load_dwordx4 v[84:87], v2, s[44:47], s49 offen nt
  s_add_u32 s49, s49, 4096
  v_and_b32_dpp v60, v54, v4 row_newbcast:0 row_mask:0xf bank_mask:0xf
  v_and_b32_dpp v61, v54, v5 row_newbcast:0 row_mask:0xf bank_mask:0xf
  v_and_b32_dpp v62, v54, v6 row_newbcast:0 row_mask:0xf bank_mask:0xf
  v_and_b32_dpp v63, v54, v7 row_newbcast:0 row_mask:0xf bank_mask:0xf
  v_mfma_f32_16x16x32_bf16 v[12:15], v[64:67], v[108:111], v[12:15]
  s_waitcnt vmcnt(4)
  buffer_load_dwordx4 v[88:91], v2, s[44:47], s49 offen nt
  s_add_u32 s49, s49, 4096
  v_and_b32_dpp v64, v54, v4 row_newbcast:4 row_mask:0xf bank_mask:0xf
  v_and_b32_dpp v65, v54, v5 row_newbcast:4 row_mask:0xf bank_mask:0xf
  v_and_b32_dpp v66, v54, v6 row_newbcast:4 row_mask:0xf bank_mask:0xf
  v_and_b32_dpp v67, v54, v7 row_newbcast:4 row_mask:0xf bank_mask:0xf
  v_mfma_f32_16x16x32_bf16 v[12:15], v[60:63], v[112:115], v[12:15]
  s_waitcnt vmcnt(4)
  buffer_load_dwordx4 v[92:95], v2, s[44:47], s49 offen nt
  s_add_u32 s49, s49, 4096
  v_and_b32_dpp v60, v54, v4 row_newbcast:8 row_mask:0xf bank_mask:0xf
  v_and_b32_dpp v61, v54, v5 row_newbcast:8 row_mask:0xf bank_mask:0xf
  v_and_b32_dpp v62, v54, v6 row_newbcast:8 row_mask:0xf bank_mask:0xf
  v_and_b32_dpp v63, v54, v7 row_newbcast:8 row_mask:0xf bank_mask:0xf
  v_mfma_f32_16x16x32_bf16 v[12:15], v[64:67], v[116:119], v[12:15]
  s_waitcnt vmcnt(4)
  buffer_load_dwordx4 v[96:99], v2, s[44:47], s49 offen nt
  s_add_u32 s49, s49, 4096
  v_and_b32_dpp v64, v54, v4 row_newbcast:12 row_mask:0xf bank_mask:0xf
  v_and_b32_dpp v65, v54, v5 row_newbcast:12 row_mask:0xf bank_mask:0xf
  v_and_b32_dpp v66, v54, v6 row_newbcast:12 row_mask:0xf bank_mask:0xf
  v_and_b32_dpp v67, v54, v7 row_newbcast:12 row_mask:0xf bank_mask:0xf
  v_mfma_f32_16x16x32_bf16 v[12:15], v[60:63], v[120:123], v[12:15]
  s_waitcnt vmcnt(4)
  buffer_load_dwordx4 v[100:103], v2, s[44:47], s49 offen nt
  s_add_u32 s49, s49, 4096
  v_and_b32_dpp v60, v55, v4 row_newbcast:0 row_mask:0xf bank_mask:0xf
  v_and_b32_dpp v61, v55, v5 row_newbcast:0 row_mask:0xf bank_mask:0xf
  v_and_b32_dpp v62, v55, v6 row_newbcast:0 row_mask:0xf bank_mask:0xf
  v_and_b32_dpp v63, v55, v7 row_newbcast:0 row_mask:0xf bank_mask:0xf
  v_mfma_f32_16x16x32_bf16 v[12:15], v[64:67], v[124:127], v[12:15]
  s_waitcnt vmcnt(4)
  buffer_load_dwordx4 v[104:107], v2, s[44:47], s49 offen nt
  s_add_u32 s49, s49, 4096
  v_and_b32_dpp v64, v55, v4 row_newbcast:4 row_mask:0xf bank_mask:0xf
  v_and_b32_dpp v65, v55, v5 row_newbcast:4 row_mask:0xf bank_mask:0xf
  v_and_b32_dpp v66, v55, v6 row_newbcast:4 row_mask:0xf bank_mask:0xf
  v_and_b32_dpp v67, v55, v7 row_newbcast:4 row_mask:0xf bank_mask:0xf
  v_mfma_f32_16x16x32_bf16 v[12:15], v[60:63], v[128:131], v[12:15]
  s_waitcnt vmcnt(4)
  buffer_load_dwordx4 v[108:111], v2, s[44:47], s49 offen nt
  s_add_u32 s49, s49, 36864
  v_and_b32_dpp v60, v55, v4 row_newbcast:8 row_mask:0xf bank_mask:0xf
  v_and_b32_dpp v61, v55, v5 row_newbcast:8 row_mask:0xf bank_mask:0xf
  v_and_b32_dpp v62, v55, v6 row_newbcast:8 row_mask:0xf bank_mask:0xf
  v_and_b32_dpp v63, v55, v7 row_newbcast:8 row_mask:0xf bank_mask:0xf
  v_mfma_f32_16x16x32_bf16 v[12:15], v[64:67], v[132:135], v[12:15]
  s_waitcnt vmcnt(4)
  buffer_load_dwordx4 v[112:115], v2, s[44:47], s49 offen nt
  s_add_u32 s49, s49, 4096
  v_and_b32_dpp v64, v55, v4 row_newbcast:12 row_mask:0xf bank_mask:0xf
  v_and_b32_dpp v65, v55, v5 row_newbcast:12 row_mask:0xf bank_mask:0xf
  v_and_b32_dpp v66, v55, v6 row_newbcast:12 row_mask:0xf bank_mask:0xf
  v_and_b32_dpp v67, v55, v7 row_newbcast:12 row_mask:0xf bank_mask:0xf
  v_mfma_f32_16x16x32_bf16 v[12:15], v[60:63], v[136:139], v[12:15]
  s_waitcnt vmcnt(4)
  buffer_load_dwordx4 v[116:119], v2, s[44:47], s49 offen nt
  s_add_u32 s49, s49, 4096
  v_mfma_f32_16x16x32_bf16 v[12:15], v[64:67], v[140:143], v[12:15]
  s_add_u32 s56, s56, 1
  s_waitcnt lgkmcnt(0)
  v_readfirstlane_b32 s59, v74
  v_mov_b32 v72, s56
  ds_write_b32 v71, v72
  s_lshr_b32 s58, s59, 8
  s_and_b32 s59, s59, 0xff
  s_min_u32 s58, s58, 30
  s_cmp_lt_u32 s56, s58
  s_cbranch_scc1 L_vloop4
  s_min_u32 s59, s59, 30
  s_cmp_lt_u32 s56, s59
  s_cbranch_scc1 L_vloop3
  s_cmp_lt_u32 s56, 30
  s_cbranch_scc1 L_vloop
  s_branch L_vloop2
.p2align 6
L_vloop4:
  s_waitcnt lgkmcnt(0)
  v_mov_b32 v52, v48
  v_mov_b32 v53, v49
  v_mov_b32 v54, v50
  v_mov_b32 v55, v51
  v_mov_b32 v56, v57
  ds_read_b128 v[48:51], v8 offset:1024
  ds_read_b32 v57, v9 offset:256
  ds_read_b32 v74, v71 offset:16
  v_add_u32 v8, 0x400, v8
  v_add_u32 v9, 0x100, v9
  v_and_b32_dpp v60, v52, v4 row_newbcast:0 row_mask:0xf bank_mask:0xf
  v_and_b32_dpp v61, v52, v5 row_newbcast:0 row_mask:0xf bank_mask:0xf
  v_and_b32_dpp v62, v52, v6 row_newbcast:0 row_mask:0xf bank_mask:0xf
  v_and_b32_dpp v63, v52, v7 row_newbcast:0 row_mask:0xf bank_mask:0xf
  v_mul_f32 v12, v56, v12
  v_mul_f32 v13, v56, v13
  v_mul_f32 v14, v56, v14
  v_mul_f32 v15, v56, v15
  s_waitcnt vmcnt(6)
  buffer_load_dwordx4 v[120:123], v2, s[44:47], s49 offen nt
  s_add_u32 s49, s49, 4096
  v_and_b32_dpp v64, v52, v4 row_newbcast:4 row_mask:0xf bank_mask:0xf
  v_and_b32_dpp v65, v52, v5 row_newbcast:4 row_mask:0xf bank_mask:0xf
  v_and_b32_dpp v66, v52, v6 row_newbcast:4 row_mask:0xf bank_mask:0xf
  v_and_b32_dpp v67, v52, v7 row_newbcast:4 row_mask:0xf bank_mask:0xf
  v_mfma_f32_16x16x32_bf16 v[12:15], v[60:63], v[80:83], v[12:15]
  s_waitcnt vmcnt(6)
  buffer_load_dwordx4 v[124:127], v2, s[44:47], s49 offen nt
  s_add_u32 s49, s49, 4096
  v_and_b32_dpp v60, v52, v4 row_newbcast:8 row_mask:0xf bank_mask:0xf
  v_and_b32_dpp v61, v52, v5 row_newbcast:8 row_mask:0xf bank_mask:0xf
  v_and_b32_dpp v62, v52, v6 row_newbcast:8 row_mask:0xf bank_mask:0xf
  v_and_b32_dpp v63, v52, v7 row_newbcast:8 row_mask:0xf bank_mask:0xf
  v_mfma_f32_16x16x32_bf16 v[12:15], v[64:67], v[84:87], v[12:15]
  s_waitcnt vmcnt(6)
  buffer_load_dwordx4 v[128:131], v2, s[44:47], s49 offen nt
  s_add_u32 s49, s49, 4096
  v_and_b32_dpp v64, v52, v4 row_newbcast:12 row_mask:0xf bank_mask:0xf
  v_and_b32_dpp v65, v52, v5 row_newbcast:12 row_mask:0xf bank_mask:0xf
  v_and_b32_dpp v66, v52, v6 row_newbcast:12 row_mask:0xf bank_mask:0xf
  v_and_b32_dpp v67, v52, v7 row_newbcast:12 row_mask:0xf bank_mask:0xf
  v_mfma_f32_16x16x32_bf16 v[12:15], v[60:63], v[88:91], v[12:15]
  s_waitcnt vmcnt(6)
  buffer_load_dwordx4 v[132:135], v2, s[44:47], s49 offen nt
  s_add_u32 s49, s49, 4096
  v_and_b32_dpp v60, v53, v4 row_newbcast:0 row_mask:0xf bank_mask:0xf
  v_and_b32_dpp v61, v53, v5 row_newbcast:0 row_mask:0xf bank_mask:0xf
  v_and_b32_dpp v62, v53, v6 row_newbcast:0 row_mask:0xf bank_mask:0xf
  v_and_b32_dpp v63, v53, v7 row_newbcast:0 row_mask:0xf bank_mask:0xf
  v_mfma_f32_16x16x32_bf16 v[12:15], v[64:67], v[92:95], v[12:15]
  s_waitcnt vmcnt(6)
  buffer_load_dwordx4 v[136:139], v2, s[44:47], s49 offen nt
  s_add_u32 s49, s49, 4096
  v_and_b32_dpp v64, v53, v4 row_newbcast:4 row_mask:0xf bank_mask:0xf
  v_and_b32_dpp v65, v53, v5 row_newbcast:4 row_mask:0xf bank_mask:0xf
  v_and_b32_dpp v66, v53, v6 row_newbcast:4 row_mask:0xf bank_mask:0xf
  v_and_b32_dpp v67, v53, v7 row_newbcast:4 row_mask:0xf bank_mask:0xf
  v_mfma_f32_16x16x32_bf16 v[12:15], v[60:63], v[96:99], v[12:15]
  s_waitcnt vmcnt(6)
  buffer_load_dwordx4 v[140:143], v2, s[44:47], s49 offen nt
  s_add_u32 s49, s49, 36864
  v_and_b32_dpp v60, v53, v4 row_newbcast:8 row_mask:0xf bank_mask:0xf
  v_and_b32_dpp v61, v53, v5 row_newbcast:8 row_mask:0xf bank_mask:0xf
  v_and_b32_dpp v62, v53, v6 row_newbcast:8 row_mask:0xf bank_mask:0xf
  v_and_b32_dpp v63, v53, v7 row_newbcast:8 row_mask:0xf bank_mask:0xf
  v_mfma_f32_16x16x32_bf16 v[12:15], v[64:67], v[100:103], v[12:15]
  s_waitcnt vmcnt(6)
  buffer_load_dwordx4 v[80:83], v2, s[44:47], s49 offen nt
  s_add_u32 s49, s49, 4096
  v_and_b32_dpp v64, v53, v4 row_newbcast:12 row_mask:0xf bank_mask:0xf
  v_and_b32_dpp v65, v53, v5 row_newbcast:12 row_mask:0xf bank_mask:0xf
  v_and_b32_dpp v66, v53, v6 row_newbcast:12 row_mask:0xf bank_mask:0xf
  v_and_b32_dpp v67, v53, v7 row_newbcast:12 row_mask:0xf bank_mask:0xf
  v_mfma_f32_16x16x32_bf16 v[12:15], v[60:63], v[104:107], v[12:15]
  s_waitcnt vmcnt(6)
  buffer_load_dwordx4 v[84:87], v2, s[44:47], s49 offen nt
  s_add_u32 s49, s49, 4096
  v_and_b32_dpp v60, v54, v4 row_newbcast:0 row_mask:0xf bank_mask:0xf
  v_and_b32_dpp v61, v54, v5 row_newbcast:0 row_mask:0xf bank_mask:0xf
  v_and_b32_dpp v62, v54, v6 row_newbcast:0 row_mask:0xf bank_mask:0xf
  v_and_b32_dpp v63, v54, v7 row_newbcast:0 row_mask:0xf bank_mask:0xf
  v_mfma_f32_16x16x32_bf16 v[12:15], v[64:67], v[108:111], v[12:15]
  s_waitcnt vmcnt(6)
  buffer_load_dwordx4 v[88:91], v2, s[44:47], s49 offen nt
  s_add_u32 s49, s49, 4096
  v_and_b32_dpp v64, v54, v4 row_newbcast:4 row_mask:0xf bank_mask:0xf
  v_and_b32_dpp v65, v54, v5 row_newbcast:4 row_mask:0xf bank_mask:0xf
  v_and_b32_dpp v66, v54, v6 row_newbcast:4 row_mask:0xf bank_mask:0xf
  v_and_b32_dpp v67, v54, v7 row_newbcast:4 row_mask:0xf bank_mask:0xf
  v_mfma_f32_16x16x32_bf16 v[12:15], v[60:63], v[112:115], v[12:15]
  s_waitcnt vmcnt(6)
  buffer_load_dwordx4 v[92:95], v2, s[44:47], s49 offen nt
  s_add_u32 s49, s49, 4096
  v_and_b32_dpp v60, v54, v4 row_newbcast:8 row_mask:0xf bank_mask:0xf
  v_and_b32_dpp v61, v54, v5 row_newbcast:8 row_mask:0xf bank_mask:0xf
  v_and_b32_dpp v62, v54, v6 row_newbcast:8 row_mask:0xf bank_mask:0xf
  v_and_b32_dpp v63, v54, v7 row_newbcast:8 row_mask:0xf bank_mask:0xf
  v_mfma_f32_16x16x32_bf16 v[12:15], v[64:67], v[116:119], v[12:15]
  s_waitcnt vmcnt(6)
  buffer_load_dwordx4 v[96:99], v2, s[44:47], s49 offen nt
  s_add_u32 s49, s49, 4096
  v_and_b32_dpp v64, v54, v4 row_newbcast:12 row_mask:0xf bank_mask:0xf
  v_and_b32_dpp v65, v54, v5 row_newbcast:12 row_mask:0xf bank_mask:0xf
  v_and_b32_dpp v66, v54, v6 row_newbcast:12 row_mask:0xf bank_mask:0xf
  v_and_b32_dpp v67, v54, v7 row_newbcast:12 row_mask:0xf bank_mask:0xf
  v_mfma_f32_16x16x32_bf16 v[12:15], v[60:63], v[120:123], v[12:15]
  s_waitcnt vmcnt(6)
  buffer_load_dwordx4 v[100:103], v2, s[44:47], s49 offen nt
  s_add_u32 s49, s49, 4096
  v_and_b32_dpp v60, v55, v4 row_newbcast:0 row_mask:0xf bank_mask:0xf
  v_and_b32_dpp v61, v55, v5 row_newbcast:0 row_mask:0xf bank_mask:0xf
  v_and_b32_dpp v62, v55, v6 row_newbcast:0 row_mask:0xf bank_mask:0xf
  v_and_b32_dpp v63, v55, v7 row_newbcast:0 row_mask:0xf bank_mask:0xf
  v_mfma_f32_16x16x32_bf16 v[12:15], v[64:67], v[124:127], v[12:15]
  s_waitcnt vmcnt(6)
  buffer_load_dwordx4 v[104:107], v2, s[44:47], s49 offen nt
  s_add_u32 s49, s49, 4096
  v_and_b32_dpp v64, v55, v4 row_newbcast:4 row_mask:0xf bank_mask:0xf
  v_and_b32_dpp v65, v55, v5 row_newbcast:4 row_mask:0xf bank_mask:0xf
  v_and_b32_dpp v66, v55, v6 row_newbcast:4 row_mask:0xf bank_mask:0xf
  v_and_b32_dpp v67, v55, v7 row_newbcast:4 row_mask:0xf bank_mask:0xf
  v_mfma_f32_16x16x32_bf16 v[12:15], v[60:63], v[128:131], v[12:15]
  s_waitcnt vmcnt(6)
  buffer_load_dwordx4 v[108:111], v2, s[44:47], s49 offen nt
  s_add_u32 s49, s49, 36864
  v_and_b32_dpp v60, v55, v4 row_newbcast:8 row_mask:0xf bank_mask:0xf
  v_and_b32_dpp v61, v55, v5 row_newbcast:8 row_mask:0xf bank_mask:0xf
  v_and_b32_dpp v62, v55, v6 row_newbcast:8 row_mask:0xf bank_mask:0xf
  v_and_b32_dpp v63, v55, v7 row_newbcast:8 row_mask:0xf bank_mask:0xf
  v_mfma_f32_16x16x32_bf16 v[12:15], v[64:67], v[132:135], v[12:15]
  s_waitcnt vmcnt(6)
  buffer_load_dwordx4 v[112:115], v2, s[44:47], s49 offen nt
  s_add_u32 s49, s49, 4096
  v_and_b32_dpp v64, v55, v4 row_newbcast:12 row_mask:0xf bank_mask:0xf
  v_and_b32_dpp v65, v55, v5 row_newbcast:12 row_mask:0xf bank_mask:0xf
  v_and_b32_dpp v66, v55, v6 row_newbcast:12 row_mask:0xf bank_mask:0xf
  v_and_b32_dpp v67, v55, v7 row_newbcast:12 row_mask:0xf bank_mask:0xf
  v_mfma_f32_16x16x32_bf16 v[12:15], v[60:63], v[136:139], v[12:15]
  s_waitcnt vmcnt(6)
  buffer_load_dwordx4 v[116:119], v2, s[44:47], s49 offen nt
  s_add_u32 s49, s49, 4096
  v_mfma_f32_16x16x32_bf16 v[12:15], v[64:67], v[140:143], v[12:15]
  s_add_u32 s56, s56, 1
  s_waitcnt lgkmcnt(0)
  v_readfirstlane_b32 s59, v74
  v_mov_b32 v72, s56
  ds_write_b32 v71, v72
  s_lshr_b32 s58, s59, 8
  s_and_b32 s59, s59, 0xff
  s_min_u32 s58, s58, 30
  s_cmp_lt_u32 s56, s58
  s_cbranch_scc1 L_vloop4
  s_min_u32 s59, s59, 30
  s_cmp_lt_u32 s56, s59
  s_cbranch_scc1 L_vloop3
  s_cmp_lt_u32 s56, 30
  s_cbranch_scc1 L_vloop
  s_branch L_vloop2
L_helper2:
  s_mov_b32 s52, s36
  s_mov_b32 s53, s37
  s_mov_b32 s54, 256
  s_mov_b32 s55, 0x20000
  v_lshlrev_b32 v5, 10, v3
  v_lshl_add_u32 v5, v4, 4, v5
  s_lshl_b32 s15, s3, 8
  v_add_u32 v5, s15, v5
  v_lshlrev_b32 v6, 4, v4
  v_lshl_add_u32 v6, v3, 2, v6
  v_add_u32 v6, s15, v6
  v_perm_b32 v224, v196, v192, s58
  v_perm_b32 v225, v204, v200, s58
  v_perm_b32 v226, v212, v208, s58
  v_perm_b32 v227, v220, v216, s58
  v_perm_b32 v228, v196, v192, s59
  v_perm_b32 v229, v204, v200, s59
  v_perm_b32 v230, v212, v208, s59
  v_perm_b32 v231, v220, v216, s59
  v_perm_b32 v232, v197, v193, s58
  v_perm_b32 v233, v205, v201, s58
  v_perm_b32 v234, v213, v209, s58
  v_perm_b32 v235, v221, v217, s58
  v_perm_b32 v236, v197, v193, s59
  v_perm_b32 v237, v205, v201, s59
  v_perm_b32 v238, v213, v209, s59
  v_perm_b32 v239, v221, v217, s59
  v_perm_b32 v240, v198, v194, s58
  v_perm_b32 v241, v206, v202, s58
  v_perm_b32 v242, v214, v210, s58
  v_perm_b32 v243, v222, v218, s58
  v_perm_b32 v244, v198, v194, s59
  v_perm_b32 v245, v206, v202, s59
  v_perm_b32 v246, v214, v210, s59
  v_perm_b32 v247, v222, v218, s59
  v_perm_b32 v248, v199, v195, s58
  v_perm_b32 v249, v207, v203, s58
  v_perm_b32 v250, v215, v211, s58
  v_perm_b32 v251, v223, v219, s58
  v_perm_b32 v252, v199, v195, s59
  v_perm_b32 v253, v207, v203, s59
  v_perm_b32 v254, v215, v211, s59
  v_perm_b32 v255, v223, v219, s59
  s_sub_u32 s15, s3, 1
  s_cmp_lt_u32 s15, 2
  s_cbranch_scc1 L_wo
  s_cmp_lt_u32 s5, 28
  s_cbranch_scc1 L_glu
  s_cmp_lg_u32 s3, 0
  s_cbranch_scc1 L_wo
  v_mov_b32 v12, 0
  v_mov_b32 v13, 0
  v_mov_b32 v14, 0
  v_mov_b32 v15, 0
  s_sub_u32 s15, s2, 224
  s_mul_i32 s15, s15, 3072
  buffer_store_dwordx4 v[12:15], v2, s[48:51], s15 offen offset:0 sc1
  buffer_store_dwordx4 v[12:15], v2, s[48:51], s15 offen offset:1024 sc1
  buffer_store_dwordx4 v[12:15], v2, s[48:51], s15 offen offset:2048 sc1
  v_mov_b32 v9, 1
  s_waitcnt vmcnt(0)
  s_mov_b64 exec, 1
  buffer_atomic_add v9, off, s[52:55], 0 offset:128 sc0 sc1
  s_waitcnt vmcnt(0)
  v_readfirstlane_b32 s15, v9
  s_nop 0
  s_cmp_lg_u32 s15, 31
  s_cbranch_scc1 L_zend
  v_mov_b32 v13, 1
  buffer_store_dword v13, off, s[52:55], 0 offset:4 sc1
L_zend:
  s_mov_b64 exec, -1
  s_mov_b32 s72, 400000
spin_66:
  ds_read_b32 v11, v8 offset:6240
  s_waitcnt lgkmcnt(0)
  v_readfirstlane_b32 s71, v11
  s_nop 0
  s_cmp_ge_u32 s71, 2
  s_cbranch_scc1 spun_67
  s_sub_u32 s72, s72, 1
  s_cmp_eq_u32 s72, 0
  s_cbranch_scc1 spun_67
  s_sleep 16
  s_branch spin_66
spun_67:
  s_mov_b32 s72, 400000
spin_68:
  buffer_load_dword v11, off, s[52:55], 0 offset:4 sc1
  s_waitcnt vmcnt(0)
  v_readfirstlane_b32 s71, v11
  s_nop 0
  s_cmp_lg_u32 s71, 0
  s_cbranch_scc1 spun_69
  s_sub_u32 s72, s72, 1
  s_cmp_eq_u32 s72, 0
  s_cbranch_scc1 spun_69
  s_sleep 64
  s_branch spin_68
spun_69:
  v_mov_b32 v13, 1
  ds_write_b32 v8, v13 offset:6248
  s_branch L_wo
L_glu:
  v_lshrrev_b32 v10, 2, v4
  v_lshlrev_b32 v10, 10, v10
  v_lshl_add_u32 v10, v3, 4, v10
  v_and_b32 v7, 1, v4
  v_lshl_add_u32 v10, v7, 6, v10
  s_lshl_b32 s15, s4, 7
  v_add_u32 v10, s15, v10
  ds_read_b128 v[16:19], v10 offset:0
  v_cmp_lt_u32 vcc, 7, v4
  s_waitcnt lgkmcnt(0)
  v_mfma_f32_16x16x32_bf16 v[32:35], v[16:19], v[224:227], 0
  v_mfma_f32_16x16x32_bf16 v[36:39], v[16:19], v[228:231], 0
  v_mfma_f32_16x16x32_bf16 v[40:43], v[16:19], v[232:235], 0
  v_mfma_f32_16x16x32_bf16 v[44:47], v[16:19], v[236:239], 0
  v_mfma_f32_16x16x32_bf16 v[48:51], v[16:19], v[240:243], 0
  v_mfma_f32_16x16x32_bf16 v[52:55], v[16:19], v[244:247], 0
  v_mfma_f32_16x16x32_bf16 v[56:59], v[16:19], v[248:251], 0
  v_mfma_f32_16x16x32_bf16 v[60:63], v[16:19], v[252:255], 0
  s_nop 4
  v_cndmask_b32 v20, v32, v49, vcc
  v_cndmask_b32 v24, v48, v33, vcc
  v_cndmask_b32 v21, v36, v53, vcc
  v_cndmask_b32 v25, v52, v37, vcc
  v_cndmask_b32 v22, v40, v57, vcc
  v_cndmask_b32 v26, v56, v41, vcc
  v_cndmask_b32 v23, v44, v61, vcc
  v_cndmask_b32 v27, v60, v45, vcc
  v_add_f32_dpp v20, v24, v20 row_ror:8 row_mask:0xf bank_mask:0xf
  v_add_f32_dpp v21, v25, v21 row_ror:8 row_mask:0xf bank_mask:0xf
  v_add_f32_dpp v22, v26, v22 row_ror:8 row_mask:0xf bank_mask:0xf
  v_add_f32_dpp v23, v27, v23 row_ror:8 row_mask:0xf bank_mask:0xf
  v_mov_b32 v13, 1
  s_cmp_lg_u32 s3, 0
  s_cbranch_scc1 L_g1w
  s_mov_b32 s72, 400000
spin_70:
  ds_read_b32 v11, v8 offset:6240
  s_waitcnt lgkmcnt(0)
  v_readfirstlane_b32 s71, v11
  s_nop 0
  s_cmp_ge_u32 s71, 2
  s_cbranch_scc1 spun_71
  s_sub_u32 s72, s72, 1
  s_cmp_eq_u32 s72, 0
  s_cbranch_scc1 spun_71
  s_sleep 16
  s_branch spin_70
spun_71:
  s_mov_b32 s72, 400000
spin_72:
  buffer_load_dword v11, off, s[52:55], 0 offset:4 sc1
  s_waitcnt vmcnt(0)
  v_readfirstlane_b32 s71, v11
  s_nop 0
  s_cmp_lg_u32 s71, 0
  s_cbranch_scc1 spun_73
  s_sub_u32 s72, s72, 1
  s_cmp_eq_u32 s72, 0
  s_cbranch_scc1 spun_73
  s_sleep 64
  s_branch spin_72
spun_73:
  ds_write_b32 v8, v13 offset:6248
L_g1w:
  s_mov_b32 s72, 400000
spin_74:
  ds_read_b32 v11, v8 offset:6248
  s_waitcnt lgkmcnt(0)
  v_readfirstlane_b32 s71, v11
  s_nop 0
  s_cmp_ge_u32 s71, 1
  s_cbranch_scc1 spun_75
  s_sub_u32 s72, s72, 1
  s_cmp_eq_u32 s72, 0
  s_cbranch_scc1 spun_75
  s_sleep 8
  s_branch spin_74
spun_75:
  v_lshlrev_b32 v9, 2, v1
  s_lshl_b32 s15, s5, 11
  s_and_b32 s64, s3, 1
  s_lshl_b32 s64, s64, 10
  s_add_u32 s15, s15, s64
  s_add_u32 s15, s15, 23552
  buffer_atomic_add_f32 v20, v9, s[48:51], s15 offen offset:0 sc1
  buffer_atomic_add_f32 v21, v9, s[48:51], s15 offen offset:256 sc1
  buffer_atomic_add_f32 v22, v9, s[48:51], s15 offen offset:512 sc1
  buffer_atomic_add_f32 v23, v9, s[48:51], s15 offen offset:768 sc1
  s_lshl_b32 s15, s5, 7
  s_add_u32 s15, s15, 18432
  s_waitcnt vmcnt(0)
  s_mov_b64 exec, 1
  buffer_atomic_add v13, off, s[48:51], s15 sc1
  s_mov_b64 exec, -1
L_wo:
  s_mov_b32 s72, 400000
spin_76:
  ds_read_b32 v11, v8 offset:6240
  s_waitcnt lgkmcnt(0)
  v_readfirstlane_b32 s71, v11
  s_nop 0
  s_cmp_ge_u32 s71, 2
  s_cbranch_scc1 spun_77
  s_sub_u32 s72, s72, 1
  s_cmp_eq_u32 s72, 0
  s_cbranch_scc1 spun_77
  s_sleep 16
  s_branch spin_76
spun_77:
  s_lshl_b32 s15, s7, 17
  s_add_u32 s40, s24, s15
  s_addc_u32 s41, s25, 0
  s_mov_b32 s42, 131072
  s_mov_b32 s43, 0x20000
  buffer_load_dword v10, v6, s[44:47], s12 offen
  s_mov_b32 s15, 0
  buffer_load_dwordx4 v[192:195], v5, s[40:43], s15 offen
  s_waitcnt vmcnt(0)
  s_mov_b32 s15, 4096
  buffer_load_dwordx4 v[196:199], v5, s[40:43], s15 offen
  s_waitcnt vmcnt(0)
  s_mov_b32 s15, 8192
  buffer_load_dwordx4 v[200:203], v5, s[40:43], s15 offen
  s_waitcnt vmcnt(0)
  s_mov_b32 s15, 12288
  buffer_load_dwordx4 v[204:207], v5, s[40:43], s15 offen
  s_waitcnt vmcnt(0)
  s_mov_b32 s15, 16384
  buffer_load_dwordx4 v[208:211], v5, s[40:43], s15 offen
  s_waitcnt vmcnt(0)
  s_mov_b32 s15, 20480
  buffer_load_dwordx4 v[212:215], v5, s[40:43], s15 offen
  s_waitcnt vmcnt(0)
  s_mov_b32 s15, 24576
  buffer_load_dwordx4 v[216:219], v5, s[40:43], s15 offen
  s_waitcnt vmcnt(0)
  s_mov_b32 s15, 28672
  buffer_load_dwordx4 v[220:223], v5, s[40:43], s15 offen
  s_waitcnt vmcnt(0)
  v_perm_b32 v64, v196, v192, s58
  v_perm_b32 v65, v204, v200, s58
  v_perm_b32 v66, v212, v208, s58
  v_perm_b32 v67, v220, v216, s58
  v_perm_b32 v68, v196, v192, s59
  v_perm_b32 v69, v204, v200, s59
  v_perm_b32 v70, v212, v208, s59
  v_perm_b32 v71, v220, v216, s59
  v_perm_b32 v72, v197, v193, s58
  v_perm_b32 v73, v205, v201, s58
  v_perm_b32 v74, v213, v209, s58
  v_perm_b32 v75, v221, v217, s58
  v_perm_b32 v76, v197, v193, s59
  v_perm_b32 v77, v205, v201, s59
  v_perm_b32 v78, v213, v209, s59
  v_perm_b32 v79, v221, v217, s59
  v_perm_b32 v80, v198, v194, s58
  v_perm_b32 v81, v206, v202, s58
  v_perm_b32 v82, v214, v210, s58
  v_perm_b32 v83, v222, v218, s58
  v_perm_b32 v84, v198, v194, s59
  v_perm_b32 v85, v206, v202, s59
  v_perm_b32 v86, v214, v210, s59
  v_perm_b32 v87, v222, v218, s59
  v_perm_b32 v88, v199, v195, s58
  v_perm_b32 v89, v207, v203, s58
  v_perm_b32 v90, v215, v211, s58
  v_perm_b32 v91, v223, v219, s58
  v_perm_b32 v92, v199, v195, s59
  v_perm_b32 v93, v207, v203, s59
  v_perm_b32 v94, v215, v211, s59
  v_perm_b32 v95, v223, v219, s59
  s_mov_b32 s15, 32768
  buffer_load_dwordx4 v[192:195], v5, s[40:43], s15 offen
  s_waitcnt vmcnt(0)
  s_mov_b32 s15, 36864
  buffer_load_dwordx4 v[196:199], v5, s[40:43], s15 offen
  s_waitcnt vmcnt(0)
  s_mov_b32 s15, 40960
  buffer_load_dwordx4 v[200:203], v5, s[40:43], s15 offen
  s_waitcnt vmcnt(0)
  s_mov_b32 s15, 45056
  buffer_load_dwordx4 v[204:207], v5, s[40:43], s15 offen
  s_waitcnt vmcnt(0)
  s_mov_b32 s15, 49152
  buffer_load_dwordx4 v[208:211], v5, s[40:43], s15 offen
  s_waitcnt vmcnt(0)
  s_mov_b32 s15, 53248
  buffer_load_dwordx4 v[212:215], v5, s[40:43], s15 offen
  s_waitcnt vmcnt(0)
  s_mov_b32 s15, 57344
  buffer_load_dwordx4 v[216:219], v5, s[40:43], s15 offen
  s_waitcnt vmcnt(0)
  s_mov_b32 s15, 61440
  buffer_load_dwordx4 v[220:223], v5, s[40:43], s15 offen
  s_waitcnt vmcnt(0)
  v_perm_b32 v96, v196, v192, s58
  v_perm_b32 v97, v204, v200, s58
  v_perm_b32 v98, v212, v208, s58
  v_perm_b32 v99, v220, v216, s58
  v_perm_b32 v100, v196, v192, s59
  v_perm_b32 v101, v204, v200, s59
  v_perm_b32 v102, v212, v208, s59
  v_perm_b32 v103, v220, v216, s59
  v_perm_b32 v104, v197, v193, s58
  v_perm_b32 v105, v205, v201, s58
  v_perm_b32 v106, v213, v209, s58
  v_perm_b32 v107, v221, v217, s58
  v_perm_b32 v108, v197, v193, s59
  v_perm_b32 v109, v205, v201, s59
  v_perm_b32 v110, v213, v209, s59
  v_perm_b32 v111, v221, v217, s59
  v_perm_b32 v112, v198, v194, s58
  v_perm_b32 v113, v206, v202, s58
  v_perm_b32 v114, v214, v210, s58
  v_perm_b32 v115, v222, v218, s58
  v_perm_b32 v116, v198, v194, s59
  v_perm_b32 v117, v206, v202, s59
  v_perm_b32 v118, v214, v210, s59
  v_perm_b32 v119, v222, v218, s59
  v_perm_b32 v120, v199, v195, s58
  v_perm_b32 v121, v207, v203, s58
  v_perm_b32 v122, v215, v211, s58
  v_perm_b32 v123, v223, v219, s58
  v_perm_b32 v124, v199, v195, s59
  v_perm_b32 v125, v207, v203, s59
  v_perm_b32 v126, v215, v211, s59
  v_perm_b32 v127, v223, v219, s59
  s_mov_b32 s15, 65536
  buffer_load_dwordx4 v[192:195], v5, s[40:43], s15 offen
  s_waitcnt vmcnt(0)
  s_mov_b32 s15, 69632
  buffer_load_dwordx4 v[196:199], v5, s[40:43], s15 offen
  s_waitcnt vmcnt(0)
  s_mov_b32 s15, 73728
  buffer_load_dwordx4 v[200:203], v5, s[40:43], s15 offen
  s_waitcnt vmcnt(0)
  s_mov_b32 s15, 77824
  buffer_load_dwordx4 v[204:207], v5, s[40:43], s15 offen
  s_waitcnt vmcnt(0)
  s_mov_b32 s15, 81920
  buffer_load_dwordx4 v[208:211], v5, s[40:43], s15 offen
  s_waitcnt vmcnt(0)
  s_mov_b32 s15, 86016
  buffer_load_dwordx4 v[212:215], v5, s[40:43], s15 offen
  s_waitcnt vmcnt(0)
  s_mov_b32 s15, 90112
  buffer_load_dwordx4 v[216:219], v5, s[40:43], s15 offen
  s_waitcnt vmcnt(0)
  s_mov_b32 s15, 94208
  buffer_load_dwordx4 v[220:223], v5, s[40:43], s15 offen
  s_waitcnt vmcnt(0)
  v_perm_b32 v128, v196, v192, s58
  v_perm_b32 v129, v204, v200, s58
  v_perm_b32 v130, v212, v208, s58
  v_perm_b32 v131, v220, v216, s58
  v_perm_b32 v132, v196, v192, s59
  v_perm_b32 v133, v204, v200, s59
  v_perm_b32 v134, v212, v208, s59
  v_perm_b32 v135, v220, v216, s59
  v_perm_b32 v136, v197, v193, s58
  v_perm_b32 v137, v205, v201, s58
  v_perm_b32 v138, v213, v209, s58
  v_perm_b32 v139, v221, v217, s58
  v_perm_b32 v140, v197, v193, s59
  v_perm_b32 v141, v205, v201, s59
  v_perm_b32 v142, v213, v209, s59
  v_perm_b32 v143, v221, v217, s59
  v_perm_b32 v144, v198, v194, s58
  v_perm_b32 v145, v206, v202, s58
  v_perm_b32 v146, v214, v210, s58
  v_perm_b32 v147, v222, v218, s58
  v_perm_b32 v148, v198, v194, s59
  v_perm_b32 v149, v206, v202, s59
  v_perm_b32 v150, v214, v210, s59
  v_perm_b32 v151, v222, v218, s59
  v_perm_b32 v152, v199, v195, s58
  v_perm_b32 v153, v207, v203, s58
  v_perm_b32 v154, v215, v211, s58
  v_perm_b32 v155, v223, v219, s58
  v_perm_b32 v156, v199, v195, s59
  v_perm_b32 v157, v207, v203, s59
  v_perm_b32 v158, v215, v211, s59
  v_perm_b32 v159, v223, v219, s59
  s_mov_b32 s15, 98304
  buffer_load_dwordx4 v[192:195], v5, s[40:43], s15 offen
  s_waitcnt vmcnt(0)
  s_mov_b32 s15, 102400
  buffer_load_dwordx4 v[196:199], v5, s[40:43], s15 offen
  s_waitcnt vmcnt(0)
  s_mov_b32 s15, 106496
  buffer_load_dwordx4 v[200:203], v5, s[40:43], s15 offen
  s_waitcnt vmcnt(0)
  s_mov_b32 s15, 110592
  buffer_load_dwordx4 v[204:207], v5, s[40:43], s15 offen
  s_waitcnt vmcnt(0)
  s_mov_b32 s15, 114688
  buffer_load_dwordx4 v[208:211], v5, s[40:43], s15 offen
  s_waitcnt vmcnt(0)
  s_mov_b32 s15, 118784
  buffer_load_dwordx4 v[212:215], v5, s[40:43], s15 offen
  s_waitcnt vmcnt(0)
  s_mov_b32 s15, 122880
  buffer_load_dwordx4 v[216:219], v5, s[40:43], s15 offen
  s_waitcnt vmcnt(0)
  s_mov_b32 s15, 126976
  buffer_load_dwordx4 v[220:223], v5, s[40:43], s15 offen
  s_waitcnt vmcnt(0)
  v_perm_b32 v160, v196, v192, s58
  v_perm_b32 v161, v204, v200, s58
  v_perm_b32 v162, v212, v208, s58
  v_perm_b32 v163, v220, v216, s58
  v_perm_b32 v164, v196, v192, s59
  v_perm_b32 v165, v204, v200, s59
  v_perm_b32 v166, v212, v208, s59
  v_perm_b32 v167, v220, v216, s59
  v_perm_b32 v168, v197, v193, s58
  v_perm_b32 v169, v205, v201, s58
  v_perm_b32 v170, v213, v209, s58
  v_perm_b32 v171, v221, v217, s58
  v_perm_b32 v172, v197, v193, s59
  v_perm_b32 v173, v205, v201, s59
  v_perm_b32 v174, v213, v209, s59
  v_perm_b32 v175, v221, v217, s59
  v_perm_b32 v176, v198, v194, s58
  v_perm_b32 v177, v206, v202, s58
  v_perm_b32 v178, v214, v210, s58
  v_perm_b32 v179, v222, v218, s58
  v_perm_b32 v180, v198, v194, s59
  v_perm_b32 v181, v206, v202, s59
  v_perm_b32 v182, v214, v210, s59
  v_perm_b32 v183, v222, v218, s59
  v_perm_b32 v184, v199, v195, s58
  v_perm_b32 v185, v207, v203, s58
  v_perm_b32 v186, v215, v211, s58
  v_perm_b32 v187, v223, v219, s58
  v_perm_b32 v188, v199, v195, s59
  v_perm_b32 v189, v207, v203, s59
  v_perm_b32 v190, v215, v211, s59
  v_perm_b32 v191, v223, v219, s59
  s_cmp_eq_u32 s3, 1
  s_cbranch_scc1 L_h1
  s_cmp_lg_u32 s3, 3
  s_cbranch_scc1 L_not3
  s_mov_b32 s72, 400000
spin_78:
  ds_read_b32 v11, v8 offset:6248
  s_waitcnt lgkmcnt(0)
  v_readfirstlane_b32 s71, v11
  s_nop 0
  s_cmp_ge_u32 s71, 1
  s_cbranch_scc1 spun_79
  s_sub_u32 s72, s72, 1
  s_cmp_eq_u32 s72, 0
  s_cbranch_scc1 spun_79
  s_sleep 16
  s_branch spin_78
spun_79:
  s_getreg_b32 s64, hwreg(HW_REG_XCC_ID, 0, 3)
  s_add_u32 s64, s64, 2
  s_bfe_u32 s64, s64, 0x10002
  s_and_b32 s65, s5, 7
  s_mul_i32 s64, s64, 8
  s_add_u32 s64, s64, s65
  s_lshl_b32 s64, s64, 7
  s_add_u32 s64, s64, 90112
  s_mov_b32 s72, 400000
spin_80:
  ds_read_b32 v11, v8 offset:6240
  s_waitcnt lgkmcnt(0)
  v_readfirstlane_b32 s71, v11
  s_nop 0
  s_cmp_ge_u32 s71, 16
  s_cbranch_scc1 spun_81
  s_sub_u32 s72, s72, 1
  s_cmp_eq_u32 s72, 0
  s_cbranch_scc1 spun_81
  s_sleep 2
  s_branch spin_80
spun_81:
  s_mov_b32 s15, 1
  s_atomic_add s15, s[38:39], s64 glc
  s_add_u32 s64, s64, 2048
  s_waitcnt lgkmcnt(0)
  s_mul_i32 s15, s15, 4
  s_add_u32 s15, s15, 2
  s_max_u32 s65, s15, 24
  s_sub_u32 s65, s65, 24
  s_lshr_b32 s65, s65, 4
  s_cselect_b32 s70, 18, 0
  s_add_u32 s65, s65, s70
  s_lshl_b32 s65, s65, 8
  s_min_u32 s15, s15, 35
  s_sub_u32 s15, 35, s15
  s_lshr_b32 s15, s15, 4
  s_cselect_b32 s70, 18, 0
  s_add_u32 s15, s15, s70
  s_add_u32 s15, s15, s65
  v_mov_b32 v13, s15
  ds_write_b32 v8, v13 offset:6256
  s_mov_b32 s72, 400000
spin_82:
  ds_read_b32 v11, v8 offset:6240
  s_waitcnt lgkmcnt(0)
  v_readfirstlane_b32 s71, v11
  s_nop 0
  s_cmp_ge_u32 s71, 19
  s_cbranch_scc1 spun_83
  s_sub_u32 s72, s72, 1
  s_cmp_eq_u32 s72, 0
  s_cbranch_scc1 spun_83
  s_sleep 2
  s_branch spin_82
spun_83:
  s_mov_b32 s15, 1
  s_atomic_add s15, s[38:39], s64 glc
  s_add_u32 s64, s64, 2048
  s_waitcnt lgkmcnt(0)
  s_mul_i32 s15, s15, 4
  s_add_u32 s15, s15, 2
  s_max_u32 s65, s15, 24
  s_sub_u32 s65, s65, 24
  s_lshr_b32 s65, s65, 4
  s_cselect_b32 s70, 21, 0
  s_add_u32 s65, s65, s70
  s_lshl_b32 s65, s65, 8
  s_min_u32 s15, s15, 35
  s_sub_u32 s15, 35, s15
  s_lshr_b32 s15, s15, 4
  s_cselect_b32 s70, 21, 0
  s_add_u32 s15, s15, s70
  s_add_u32 s15, s15, s65
  v_mov_b32 v13, s15
  ds_write_b32 v8, v13 offset:6256
  s_mov_b32 s72, 400000
spin_84:
  ds_read_b32 v11, v8 offset:6240
  s_waitcnt lgkmcnt(0)
  v_readfirstlane_b32 s71, v11
  s_nop 0
  s_cmp_ge_u32 s71, 22
  s_cbranch_scc1 spun_85
  s_sub_u32 s72, s72, 1
  s_cmp_eq_u32 s72, 0
  s_cbranch_scc1 spun_85
  s_sleep 2
  s_branch spin_84
spun_85:
  s_mov_b32 s15, 1
  s_atomic_add s15, s[38:39], s64 glc
  s_add_u32 s64, s64, 2048
  s_waitcnt lgkmcnt(0)
  s_mul_i32 s15, s15, 4
  s_add_u32 s15, s15, 2
  s_max_u32 s65, s15, 24
  s_sub_u32 s65, s65, 24
  s_lshr_b32 s65, s65, 4
  s_cselect_b32 s70, 24, 0
  s_add_u32 s65, s65, s70
  s_lshl_b32 s65, s65, 8
  s_min_u32 s15, s15, 35
  s_sub_u32 s15, 35, s15
  s_lshr_b32 s15, s15, 4
  s_cselect_b32 s70, 24, 0
  s_add_u32 s15, s15, s70
  s_add_u32 s15, s15, s65
  v_mov_b32 v13, s15
  ds_write_b32 v8, v13 offset:6256
  s_mov_b32 s72, 400000
spin_86:
  ds_read_b32 v11, v8 offset:6240
  s_waitcnt lgkmcnt(0)
  v_readfirstlane_b32 s71, v11
  s_nop 0
  s_cmp_ge_u32 s71, 25
  s_cbranch_scc1 spun_87
  s_sub_u32 s72, s72, 1
  s_cmp_eq_u32 s72, 0
  s_cbranch_scc1 spun_87
  s_sleep 2
  s_branch spin_86
spun_87:
  s_mov_b32 s15, 1
  s_atomic_add s15, s[38:39], s64 glc
  s_add_u32 s64, s64, 2048
  s_waitcnt lgkmcnt(0)
  s_mul_i32 s15, s15, 4
  s_add_u32 s15, s15, 2
  s_max_u32 s65, s15, 24
  s_sub_u32 s65, s65, 24
  s_lshr_b32 s65, s65, 4
  s_cselect_b32 s70, 27, 0
  s_add_u32 s65, s65, s70
  s_lshl_b32 s65, s65, 8
  s_min_u32 s15, s15, 35
  s_sub_u32 s15, 35, s15
  s_lshr_b32 s15, s15, 4
  s_cselect_b32 s70, 27, 0
  s_add_u32 s15, s15, s70
  s_add_u32 s15, s15, s65
  v_mov_b32 v13, s15
  ds_write_b32 v8, v13 offset:6256
  s_branch L_fin
L_not3:
  s_cmp_lg_u32 s3, 2
  s_cbranch_scc1 L_fin
  s_cmp_ge_u32 s5, 28
  s_cbranch_scc1 L_fin
L_g2:
  s_mov_b32 s72, 400000
spin_88:
  ds_read_b32 v11, v8 offset:6248
  s_waitcnt lgkmcnt(0)
  v_readfirstlane_b32 s71, v11
  s_nop 0
  s_cmp_ge_u32 s71, 1
  s_cbranch_scc1 spun_89
  s_sub_u32 s72, s72, 1
  s_cmp_eq_u32 s72, 0
  s_cbranch_scc1 spun_89
  s_sleep 16
  s_branch spin_88
spun_89:
  s_mov_b32 s72, 400000
spin_90:
  ds_read_b32 v11, v8 offset:6240
  s_waitcnt lgkmcnt(0)
  v_readfirstlane_b32 s71, v11
  s_nop 0
  s_cmp_ge_u32 s71, 8
  s_cbranch_scc1 spun_91
  s_sub_u32 s72, s72, 1
  s_cmp_eq_u32 s72, 0
  s_cbranch_scc1 spun_91
  s_sleep 16
  s_branch spin_90
spun_91:
  s_lshl_b32 s64, s5, 7
  s_add_u32 s64, s64, 18432
  s_mov_b32 s72, 400000
spin_92:
  buffer_load_dword v11, off, s[48:51], s64 sc1
  s_waitcnt vmcnt(0)
  v_readfirstlane_b32 s71, v11
  s_nop 0
  s_cmp_ge_u32 s71, 16
  s_cbranch_scc1 spun_93
  s_sub_u32 s72, s72, 1
  s_cmp_eq_u32 s72, 0
  s_cbranch_scc1 spun_93
  s_sleep 64
  s_branch spin_92
spun_93:
  v_lshlrev_b32 v9, 2, v1
  s_lshl_b32 s15, s5, 11
  s_add_u32 s15, s15, 23552
  buffer_load_dword v192, v9, s[48:51], s15 offen offset:0 sc1
  buffer_load_dword v193, v9, s[48:51], s15 offen offset:256 sc1
  buffer_load_dword v194, v9, s[48:51], s15 offen offset:512 sc1
  buffer_load_dword v195, v9, s[48:51], s15 offen offset:768 sc1
  buffer_load_dword v196, v9, s[48:51], s15 offen offset:1024 sc1
  buffer_load_dword v197, v9, s[48:51], s15 offen offset:1280 sc1
  buffer_load_dword v198, v9, s[48:51], s15 offen offset:1536 sc1
  buffer_load_dword v199, v9, s[48:51], s15 offen offset:1792 sc1
  v_lshlrev_b32 v14, 8, v3
  v_and_b32 v13, 7, v4
  v_lshl_add_u32 v14, v13, 4, v14
  v_lshrrev_b32 v13, 3, v4
  v_lshl_add_u32 v14, v13, 3, v14
  v_lshrrev_b32 v12, 2, v4
  v_lshlrev_b32 v12, 8, v12
  v_and_b32 v13, 1, v4
  v_lshl_add_u32 v12, v13, 6, v12
  v_lshl_add_u32 v12, v3, 4, v12
  s_waitcnt vmcnt(0)
  v_cvt_pk_bf16_f32 v192, v192, v192
  v_and_b32 v192, 0xffff0000, v192
  v_cvt_pk_bf16_f32 v193, v193, v193
  v_and_b32 v193, 0xffff0000, v193
  v_cvt_pk_bf16_f32 v194, v194, v194
  v_and_b32 v194, 0xffff0000, v194
  v_cvt_pk_bf16_f32 v195, v195, v195
  v_and_b32 v195, 0xffff0000, v195
  v_cvt_pk_bf16_f32 v196, v196, v196
  v_and_b32 v196, 0xffff0000, v196
  v_cvt_pk_bf16_f32 v197, v197, v197
  v_and_b32 v197, 0xffff0000, v197
  v_cvt_pk_bf16_f32 v198, v198, v198
  v_and_b32 v198, 0xffff0000, v198
  v_cvt_pk_bf16_f32 v199, v199, v199
  v_and_b32 v199, 0xffff0000, v199
  v_mul_f32 v208, 0xbfb8aa3b, v192
  v_exp_f32 v208, v208
  s_nop 0
  v_add_f32 v208, 1.0, v208
  v_rcp_f32 v208, v208
  s_nop 0
  v_mul_f32 v192, v192, v208
  v_mul_f32 v209, 0xbfb8aa3b, v193
  v_exp_f32 v209, v209
  s_nop 0
  v_add_f32 v209, 1.0, v209
  v_rcp_f32 v209, v209
  s_nop 0
  v_mul_f32 v193, v193, v209
  v_mul_f32 v210, 0xbfb8aa3b, v194
  v_exp_f32 v210, v210
  s_nop 0
  v_add_f32 v210, 1.0, v210
  v_rcp_f32 v210, v210
  s_nop 0
  v_mul_f32 v194, v194, v210
  v_mul_f32 v211, 0xbfb8aa3b, v195
  v_exp_f32 v211, v211
  s_nop 0
  v_add_f32 v211, 1.0, v211
  v_rcp_f32 v211, v211
  s_nop 0
  v_mul_f32 v195, v195, v211
  v_cvt_pk_bf16_f32 v192, v192, v192
  v_and_b32 v192, 0xffff0000, v192
  v_cvt_pk_bf16_f32 v193, v193, v193
  v_and_b32 v193, 0xffff0000, v193
  v_cvt_pk_bf16_f32 v194, v194, v194
  v_and_b32 v194, 0xffff0000, v194
  v_cvt_pk_bf16_f32 v195, v195, v195
  v_and_b32 v195, 0xffff0000, v195
  v_mul_f32 v192, v192, v196
  v_mul_f32 v193, v193, v197
  v_mul_f32 v194, v194, v198
  v_mul_f32 v195, v195, v199
  v_cvt_pk_bf16_f32 v200, v192, v193
  v_cvt_pk_bf16_f32 v201, v194, v195
  ds_write_b64 v14, v[200:201] offset:25600
  s_waitcnt lgkmcnt(0)
  ds_read_b128 v[16:19], v12 offset:25600
  v_cmp_lt_u32 vcc, 7, v4
  s_waitcnt lgkmcnt(0)
  v_mfma_f32_16x16x32_bf16 v[32:35], v[16:19], v[224:227], 0
  v_mfma_f32_16x16x32_bf16 v[36:39], v[16:19], v[228:231], 0
  v_mfma_f32_16x16x32_bf16 v[40:43], v[16:19], v[232:235], 0
  v_mfma_f32_16x16x32_bf16 v[44:47], v[16:19], v[236:239], 0
  v_mfma_f32_16x16x32_bf16 v[48:51], v[16:19], v[240:243], 0
  v_mfma_f32_16x16x32_bf16 v[52:55], v[16:19], v[244:247], 0
  v_mfma_f32_16x16x32_bf16 v[56:59], v[16:19], v[248:251], 0
  v_mfma_f32_16x16x32_bf16 v[60:63], v[16:19], v[252:255], 0
  s_nop 4
  v_cndmask_b32 v20, v32, v49, vcc
  v_cndmask_b32 v24, v48, v33, vcc
  v_cndmask_b32 v21, v36, v53, vcc
  v_cndmask_b32 v25, v52, v37, vcc
  v_cndmask_b32 v22, v40, v57, vcc
  v_cndmask_b32 v26, v56, v41, vcc
  v_cndmask_b32 v23, v44, v61, vcc
  v_cndmask_b32 v27, v60, v45, vcc
  v_add_f32_dpp v20, v24, v20 row_ror:8 row_mask:0xf bank_mask:0xf
  v_add_f32_dpp v21, v25, v21 row_ror:8 row_mask:0xf bank_mask:0xf
  v_add_f32_dpp v22, v26, v22 row_ror:8 row_mask:0xf bank_mask:0xf
  v_add_f32_dpp v23, v27, v23 row_ror:8 row_mask:0xf bank_mask:0xf
  s_lshl_b32 s15, s4, 10
  s_add_u32 s15, s15, 81920
  buffer_atomic_add_f32 v20, v9, s[48:51], s15 offen offset:0 sc1
  buffer_atomic_add_f32 v21, v9, s[48:51], s15 offen offset:256 sc1
  buffer_atomic_add_f32 v22, v9, s[48:51], s15 offen offset:512 sc1
  buffer_atomic_add_f32 v23, v9, s[48:51], s15 offen offset:768 sc1
  v_mov_b32 v13, 1
  s_lshl_b32 s15, s4, 7
  s_add_u32 s15, s15, 22016
  s_waitcnt vmcnt(0)
  s_mov_b64 exec, 1
  buffer_atomic_add v13, off, s[48:51], s15 sc0 sc1
  s_waitcnt vmcnt(0)
  v_readfirstlane_b32 s15, v13
  s_nop 0
  s_cmp_lg_u32 s15, 27
  s_cbranch_scc1 L_g2end
  v_mov_b32 v13, 1
  buffer_atomic_add v13, off, s[52:55], 0 offset:132 sc0 sc1
  s_waitcnt vmcnt(0)
  v_readfirstlane_b32 s15, v13
  s_nop 0
  s_cmp_lg_u32 s15, 7
  s_cbranch_scc1 L_g2end
  v_mov_b32 v13, 1
  buffer_store_dword v13, off, s[52:55], 0 offset:0 sc1
  s_add_u32 s15, s69, 1
  v_mov_b32 v14, s15
  s_mov_b32 s15, 196608
  buffer_store_dword v14, off, s[48:51], s15 sc1
L_g2end:
  s_mov_b64 exec, -1
  s_branch L_fin
L_h1:
  s_mov_b32 s72, 400000
spin_94:
  ds_read_b32 v11, v8 offset:6244
  s_waitcnt lgkmcnt(0)
  v_readfirstlane_b32 s71, v11
  s_nop 0
  s_cmp_ge_u32 s71, 256
  s_cbranch_scc1 spun_95
  s_sub_u32 s72, s72, 1
  s_cmp_eq_u32 s72, 0
  s_cbranch_scc1 spun_95
  s_sleep 16
  s_branch spin_94
spun_95:
  s_mov_b32 s72, 400000
spin_96:
  ds_read_b32 v11, v8 offset:6240
  s_waitcnt lgkmcnt(0)
  v_readfirstlane_b32 s71, v11
  s_nop 0
  s_cmp_ge_u32 s71, 20
  s_cbranch_scc1 spun_97
  s_sub_u32 s72, s72, 1
  s_cmp_eq_u32 s72, 0
  s_cbranch_scc1 spun_97
  s_sleep 16
  s_branch spin_96
spun_97:
  s_mov_b32 s72, 400000
spin_98:
  buffer_load_dword v11, off, s[52:55], 0 offset:0 sc1
  s_waitcnt vmcnt(0)
  v_readfirstlane_b32 s71, v11
  s_nop 0
  s_cmp_lg_u32 s71, 0
  s_cbranch_scc1 spun_99
  s_sub_u32 s72, s72, 1
  s_cmp_eq_u32 s72, 0
  s_cbranch_scc1 spun_99
  s_sleep 127
  s_branch spin_98
spun_99:
  ds_read_b128 v[16:19], v8 offset:6144
  ds_read_b128 v[20:23], v8 offset:6160
  s_waitcnt lgkmcnt(0)
  v_max3_f32 v24, v16, v18, v20
  v_max_f32 v24, v24, v22
  v_sub_f32 v28, v16, v24
  v_sub_f32 v29, v18, v24
  v_sub_f32 v30, v20, v24
  v_sub_f32 v31, v22, v24
  v_mul_f32 v28, 0x3fb8aa3b, v28
  v_mul_f32 v29, 0x3fb8aa3b, v29
  v_mul_f32 v30, 0x3fb8aa3b, v30
  v_mul_f32 v31, 0x3fb8aa3b, v31
  v_exp_f32 v28, v28
  v_exp_f32 v29, v29
  v_exp_f32 v30, v30
  v_exp_f32 v31, v31
  v_mul_f32 v25, v17, v28
  v_fmac_f32 v25, v19, v29
  v_fmac_f32 v25, v21, v30
  v_fmac_f32 v25, v23, v31
  s_lshl_b32 s15, s9, 5
  s_add_u32 s15, s15, 10240
  s_mov_b64 exec, 1
  v_mov_b32 v22, v24
  v_or_b32 v23, 0x80000000, v25
  buffer_store_dwordx2 v[22:23], off, s[48:51], s15 sc1
  s_mov_b64 exec, -1
  s_xor_b32 s15, s15, 32
  s_mov_b32 s72, 400000
spin_100:
  ds_read_b32 v11, v8 offset:6240
  s_waitcnt lgkmcnt(0)
  v_readfirstlane_b32 s71, v11
  s_nop 0
  s_cmp_ge_u32 s71, 22
  s_cbranch_scc1 spun_101
  s_sub_u32 s72, s72, 1
  s_cmp_eq_u32 s72, 0
  s_cbranch_scc1 spun_101
  s_sleep 16
  s_branch spin_100
spun_101:
  s_mov_b32 s72, 400000
spin_102:
  buffer_load_dwordx2 v[26:27], off, s[48:51], s15 sc1
  s_waitcnt vmcnt(0)
  v_readfirstlane_b32 s71, v27
  s_nop 0
  s_cmp_lg_u32 s71, 0
  s_cbranch_scc1 spun_103
  s_sub_u32 s72, s72, 1
  s_cmp_eq_u32 s72, 0
  s_cbranch_scc1 spun_103
  s_sleep 32
  s_branch spin_102
spun_103:
  v_and_b32 v27, 0x7fffffff, v27
  v_max_f32 v16, v24, v26
  v_sub_f32 v17, v24, v16
  v_sub_f32 v18, v26, v16
  v_mul_f32 v17, 0x3fb8aa3b, v17
  v_mul_f32 v18, 0x3fb8aa3b, v18
  v_exp_f32 v17, v17
  v_exp_f32 v18, v18
  v_mul_f32 v19, v25, v17
  v_fmac_f32 v19, v27, v18
  v_rcp_f32 v19, v19
  s_nop 0
  v_mul_f32 v19, v19, v17
  v_mul_f32 v28, v28, v19
  v_mul_f32 v29, v29, v19
  v_mul_f32 v30, v30, v19
  v_mul_f32 v31, v31, v19
  ds_write_b128 v8, v[28:31] offset:6208
L_fin:
  v_and_b32 v7, 3, v1
  v_lshlrev_b32 v7, 8, v7
  v_lshl_add_u32 v7, v3, 4, v7
  v_lshlrev_b32 v9, 2, v1
  v_cmp_eq_u32 s[62:63], 1, v3
  v_cmp_eq_u32 s[64:65], 2, v3
  v_cmp_eq_u32 s[66:67], 3, v3
  s_lshl_b32 s60, s6, 2
  s_add_u32 s60, s60, s3
  s_lshl_b32 s61, s60, 7
  s_add_u32 s61, s61, 8192
  s_lshl_b32 s60, s60, 9
  s_mov_b32 s74, s60
  v_lshrrev_b32 v229, 3, v4
  v_lshlrev_b32 v229, 10, v229
  v_and_b32 v230, 7, v4
  v_lshl_add_u32 v229, v230, 2, v229
  v_lshrrev_b32 v230, 1, v3
  v_lshl_add_u32 v229, v230, 5, v229
  v_and_b32 v230, 1, v3
  v_lshl_add_u32 v229, v230, 9, v229
  s_lshl_b32 s57, s3, 11
  s_lshl_b32 s15, s6, 6
  s_add_u32 s57, s57, s15
  s_add_u32 s57, s57, 81920
  s_mov_b32 s40, s34
  s_mov_b32 s41, s35
  s_mov_b32 s42, 4096
  s_mov_b32 s43, 0x20000
  v_lshlrev_b32 v226, 16, v10
  v_and_b32 v227, 0xffff0000, v10
  v_mov_b32 v228, 1
  s_mov_b32 s70, 1
  s_waitcnt lgkmcnt(0)
  s_barrier
  ds_read_b128 v[16:19], v7 offset:6656
  ds_read_b128 v[20:23], v7 offset:6720
  ds_read_b128 v[24:27], v7 offset:6784
  ds_read_b128 v[28:31], v7 offset:6848
  ds_read_b128 v[12:15], v8 offset:6208
  buffer_load_dword v224, v229, s[48:51], s57 offen sc1
  buffer_load_dword v225, v229, s[48:51], s57 offen offset:256 sc1
  s_waitcnt lgkmcnt(4)
  v_mfma_f32_16x16x32_bf16 v[32:35], v[16:19], v[64:67], 0
  v_mfma_f32_16x16x32_bf16 v[36:39], v[16:19], v[68:71], 0
  s_waitcnt lgkmcnt(3)
  v_mfma_f32_16x16x32_bf16 v[32:35], v[20:23], v[96:99], v[32:35]
  v_mfma_f32_16x16x32_bf16 v[36:39], v[20:23], v[100:103], v[36:39]
  s_waitcnt lgkmcnt(2)
  v_mfma_f32_16x16x32_bf16 v[32:35], v[24:27], v[128:131], v[32:35]
  v_mfma_f32_16x16x32_bf16 v[36:39], v[24:27], v[132:135], v[36:39]
  s_waitcnt lgkmcnt(1)
  v_mfma_f32_16x16x32_bf16 v[32:35], v[28:31], v[160:163], v[32:35]
  v_mfma_f32_16x16x32_bf16 v[36:39], v[28:31], v[164:167], v[36:39]
  s_waitcnt lgkmcnt(0)
  v_mfma_f32_16x16x32_bf16 v[40:43], v[16:19], v[72:75], 0
  v_mfma_f32_16x16x32_bf16 v[44:47], v[16:19], v[76:79], 0
  v_mfma_f32_16x16x32_bf16 v[40:43], v[20:23], v[104:107], v[40:43]
  v_mfma_f32_16x16x32_bf16 v[44:47], v[20:23], v[108:111], v[44:47]
  s_nop 1
  v_mul_f32 v32, v32, v12
  v_fmac_f32 v32, v33, v13
  v_mfma_f32_16x16x32_bf16 v[40:43], v[24:27], v[136:139], v[40:43]
  v_fmac_f32 v32, v34, v14
  v_fmac_f32 v32, v35, v15
  v_mfma_f32_16x16x32_bf16 v[44:47], v[24:27], v[140:143], v[44:47]
  v_mul_f32 v36, v36, v12
  v_fmac_f32 v36, v37, v13
  v_mfma_f32_16x16x32_bf16 v[40:43], v[28:31], v[168:171], v[40:43]
  v_fmac_f32 v36, v38, v14
  v_fmac_f32 v36, v39, v15
  v_mfma_f32_16x16x32_bf16 v[44:47], v[28:31], v[172:175], v[44:47]
  v_mfma_f32_16x16x32_bf16 v[48:51], v[16:19], v[80:83], 0
  v_mfma_f32_16x16x32_bf16 v[52:55], v[16:19], v[84:87], 0
  v_mfma_f32_16x16x32_bf16 v[48:51], v[20:23], v[112:115], v[48:51]
  v_mfma_f32_16x16x32_bf16 v[52:55], v[20:23], v[116:119], v[52:55]
  s_nop 0
  v_mul_f32 v40, v40, v12
  v_fmac_f32 v40, v41, v13
  v_mfma_f32_16x16x32_bf16 v[48:51], v[24:27], v[144:147], v[48:51]
  v_fmac_f32 v40, v42, v14
  v_fmac_f32 v40, v43, v15
  v_mfma_f32_16x16x32_bf16 v[52:55], v[24:27], v[148:151], v[52:55]
  v_cndmask_b32 v32, v32, v40, s[62:63]
  v_mul_f32 v44, v44, v12
  v_mfma_f32_16x16x32_bf16 v[48:51], v[28:31], v[176:179], v[48:51]
  v_fmac_f32 v44, v45, v13
  v_fmac_f32 v44, v46, v14
  v_mfma_f32_16x16x32_bf16 v[52:55], v[28:31], v[180:183], v[52:55]
  v_fmac_f32 v44, v47, v15
  v_cndmask_b32 v36, v36, v44, s[62:63]
  v_mfma_f32_16x16x32_bf16 v[56:59], v[16:19], v[88:91], 0
  v_mfma_f32_16x16x32_bf16 v[60:63], v[16:19], v[92:95], 0
  v_mfma_f32_16x16x32_bf16 v[56:59], v[20:23], v[120:123], v[56:59]
  v_mfma_f32_16x16x32_bf16 v[60:63], v[20:23], v[124:127], v[60:63]
  v_mul_f32 v48, v48, v12
  v_fmac_f32 v48, v49, v13
  v_mfma_f32_16x16x32_bf16 v[56:59], v[24:27], v[152:155], v[56:59]
  v_fmac_f32 v48, v50, v14
  v_fmac_f32 v48, v51, v15
  v_mfma_f32_16x16x32_bf16 v[60:63], v[24:27], v[156:159], v[60:63]
  v_cndmask_b32 v32, v32, v48, s[64:65]
  v_mul_f32 v52, v52, v12
  v_mfma_f32_16x16x32_bf16 v[56:59], v[28:31], v[184:187], v[56:59]
  v_fmac_f32 v52, v53, v13
  v_fmac_f32 v52, v54, v14
  v_mfma_f32_16x16x32_bf16 v[60:63], v[28:31], v[188:191], v[60:63]
  v_fmac_f32 v52, v55, v15
  v_cndmask_b32 v36, v36, v52, s[64:65]
  s_nop 2
  v_mul_f32 v56, v56, v12
  v_fmac_f32 v56, v57, v13
  v_fmac_f32 v56, v58, v14
  v_fmac_f32 v56, v59, v15
  v_cndmask_b32 v32, v32, v56, s[66:67]
  buffer_atomic_add_f32 v32, v9, s[48:51], s60 offen sc1
  v_mul_f32 v60, v60, v12
  v_fmac_f32 v60, v61, v13
  v_fmac_f32 v60, v62, v14
  v_fmac_f32 v60, v63, v15
  v_cndmask_b32 v36, v36, v60, s[66:67]
  buffer_atomic_add_f32 v36, v9, s[48:51], s60 offen offset:256 sc1
  s_mov_b64 exec, 1
  s_waitcnt vmcnt(0)
  buffer_atomic_add v228, off, s[48:51], s61 sc0 sc1
  s_mov_b64 exec, -1
  v_cvt_pk_bf16_f32 v224, v224, v224
  v_and_b32 v224, 0xffff0000, v224
  v_cvt_pk_bf16_f32 v225, v225, v225
  v_and_b32 v225, 0xffff0000, v225
  v_mul_f32 v230, 0xbfb8aa3b, v224
  v_exp_f32 v230, v230
  s_nop 0
  v_add_f32 v230, 1.0, v230
  v_rcp_f32 v230, v230
  s_nop 0
  v_mul_f32 v224, v224, v230
  v_mul_f32 v231, 0xbfb8aa3b, v225
  v_exp_f32 v231, v231
  s_nop 0
  v_add_f32 v231, 1.0, v231
  v_rcp_f32 v231, v231
  s_nop 0
  v_mul_f32 v225, v225, v231
  v_cvt_pk_bf16_f32 v224, v224, v224
  v_and_b32 v224, 0xffff0000, v224
  v_cvt_pk_bf16_f32 v225, v225, v225
  v_and_b32 v225, 0xffff0000, v225
  s_waitcnt vmcnt(0)
  v_readfirstlane_b32 s15, v228
  s_nop 0
  s_cmp_lg_u32 s15, 63
  s_cbranch_scc1 L_hend
  buffer_load_dword v32, v9, s[48:51], s74 offen offset:0 sc1
  buffer_load_dword v33, v9, s[48:51], s74 offen offset:256 sc1
  s_waitcnt vmcnt(0)
  v_cvt_pk_bf16_f32 v34, v32, v33
  v_lshlrev_b32 v32, 16, v34
  v_and_b32 v33, 0xffff0000, v34
  v_mul_f32 v32, v32, v224
  v_mul_f32 v33, v33, v225
  v_cvt_pk_bf16_f32 v34, v32, v33
  v_lshlrev_b32 v32, 16, v34
  v_and_b32 v33, 0xffff0000, v34
  v_add_f32 v32, v32, v226
  v_add_f32 v33, v33, v227
  v_cvt_pk_bf16_f32 v34, v32, v33
  buffer_store_dword v34, v6, s[40:43], s12 offen
L_hend:
L_end:
  s_endpgm
.section .rodata,"a"
.p2align 6
.amdhsa_kernel recurrent_scan__mha_block_cached__glu_gated_swiglu__decode_kernel
  .amdhsa_next_free_vgpr 256
  .amdhsa_next_free_sgpr 102
  .amdhsa_accum_offset 256
  .amdhsa_group_segment_fixed_size 0
  .amdhsa_kernarg_size 96
  .amdhsa_user_sgpr_count 2
  .amdhsa_user_sgpr_kernarg_segment_ptr 1
  .amdhsa_system_sgpr_workgroup_id_x 1
  .amdhsa_float_denorm_mode_32 3
.end_amdhsa_kernel
```
